```python
import torch

def _softmax(x, axis=-1):
    return torch.softmax(x, dim=axis)
def _gelu(x):
    return torch.nn.functional.gelu(x, approximate="tanh")
def _silu(x):
    return torch.nn.functional.silu(x)
def _sigmoid(x):
    return torch.sigmoid(x)
def _layernorm(x, axis=-1, eps=1e-5):
    m = x.mean(dim=axis, keepdim=True)
    v = x.var(dim=axis, keepdim=True, unbiased=False)
    return (x - m) / torch.sqrt(v + eps)
def _scatter_add(tgt, idx, src, axis=0):
    return tgt.clone().index_add_(axis, idx, src)
def _segment_sum(src, seg, n):
    out = torch.zeros((n,) + src.shape[1:], dtype=src.dtype)
    return out.index_add_(0, seg, src)
def _pad(x, pw):
    flat = tuple(v for pair in reversed(pw) for v in pair)
    return torch.nn.functional.pad(x, flat)

kernel_name = 'concat_heads__ssm_conv_h3__ssm_conv_s5__prompt'

def setup_inputs():

    _w = (lambda a: (lambda t: t.to(torch.bfloat16) if t.is_floating_point() else t)(torch.as_tensor(a)))
    def _A_setup():
        B, S, D = 1, 2048, 640
        ks = 4
        return {
            "q": _w((lambda *s: torch.randn(*s, dtype=torch.bfloat16) * 0.05)(B, S, D)),
            "k": _w((lambda *s: torch.randn(*s, dtype=torch.bfloat16) * 0.2)(B, S, D)),
            "v": _w((lambda *s: torch.randn(*s, dtype=torch.bfloat16) * 0.2)(B, S, D)),
            "shift_k": _w((lambda *s: torch.randn(*s, dtype=torch.bfloat16) * 0.2)(D, ks) * 0.5),
            "ssm_k": _w((lambda *s: torch.randn(*s, dtype=torch.bfloat16) * 0.8)(D, S) * (1.0 / S ** 0.5)),
            "ssm_D": _w((lambda *s: torch.randn(*s, dtype=torch.bfloat16) * 0.2)(D)),
        }
    _A_in = _A_setup()

    def _B_setup():
        B, S, D = 1, 2048, 640
        P = D
        Lambda_re = -0.5 * (lambda _x: torch.exp(torch.as_tensor(_x)))((lambda *s: torch.randn(*s, dtype=torch.bfloat16) * 0.2)(P))
        Lambda_im = (lambda *s: torch.randn(*s, dtype=torch.bfloat16) * 0.4)(P) * 1.0
        B_re = (lambda *s: torch.randn(*s, dtype=torch.bfloat16) * 0.2)(P, D) * (D ** -0.5)
        B_im = (lambda *s: torch.randn(*s, dtype=torch.bfloat16) * 0.2)(P, D) * (D ** -0.5)
        C_re = (lambda *s: torch.randn(*s, dtype=torch.bfloat16) * 0.2)(D, P) * (P ** -0.5)
        C_im = (lambda *s: torch.randn(*s, dtype=torch.bfloat16) * 0.2)(D, P) * (P ** -0.5)
        log_dt = (lambda *s: torch.randn(*s, dtype=torch.bfloat16) * 0.2)(P) * 0.3 - 2.0
        Dskip = (lambda *s: torch.randn(*s, dtype=torch.bfloat16) * 0.05)(D)
        return {
            "x": _w((lambda *s: torch.randn(*s, dtype=torch.bfloat16) * 0.05)(B, S, D)),
            "Lambda_re": _w(Lambda_re),
            "Lambda_im": _w(Lambda_im),
            "B_re": _w(B_re),
            "B_im": _w(B_im),
            "C_re": _w(C_re),
            "C_im": _w(C_im),
            "log_dt": _w(log_dt),
            "Dskip": _w(Dskip),
        }
    _B_in = _B_setup()

    return {
        "A_q": _A_in["q"],
        "A_k": _A_in["k"],
        "A_v": _A_in["v"],
        "A_shift_k": _A_in["shift_k"],
        "A_ssm_k": _A_in["ssm_k"],
        "A_ssm_D": _A_in["ssm_D"],
        "B_x": _B_in["x"],
        "B_Lambda_re": _B_in["Lambda_re"],
        "B_Lambda_im": _B_in["Lambda_im"],
        "B_B_re": _B_in["B_re"],
        "B_B_im": _B_in["B_im"],
        "B_C_re": _B_in["C_re"],
        "B_C_im": _B_in["C_im"],
        "B_log_dt": _B_in["log_dt"],
        "B_Dskip": _B_in["Dskip"],
    }

def reference(A_q, A_k, A_v, A_shift_k, A_ssm_k, A_ssm_D, B_x, B_Lambda_re, B_Lambda_im, B_B_re, B_B_im, B_C_re, B_C_im, B_log_dt, B_Dskip):
    def _A_ref(q, k, v, shift_k, ssm_k, ssm_D):
        B, S, D = q.shape
        ks = shift_k.shape[-1]
        k_pad = _pad(k, ((0, 0), (ks - 1, 0), (0, 0)))
        k_shift = torch.zeros_like(k)
        for t in range(ks):
            k_shift = k_shift + k_pad[:, t:t + S, :] * shift_k[:, ks - 1 - t][None, None, :]
        kv = k_shift * v
        L = 2 * S
        kv_pad = _pad(kv, ((0, 0), (0, S), (0, 0)))
        kf_pad = _pad(ssm_k, ((0, 0), (0, S)))
        kv_f = (lambda x, axes=(-2,-1): torch.fft.rfft2(x.float(), dim=axes))(kv_pad[:, None, :, :], axes=(1, 2))
        kf_f = (lambda x, axes=(-2,-1): torch.fft.rfft2(x.float(), dim=axes))(kf_pad[:, None, :], axes=(1, 2))
        kf_f = (lambda x, *d: x.permute(*d))(kf_f, 1, 2, 0)
        y_f = kv_f * kf_f[None, :, :, :]
        y = (lambda x, s, axes=(-2,-1): torch.fft.irfft2(x, s=s, dim=axes).to(torch.bfloat16))(y_f, (1, L), axes=(1, 2))[:, 0, :S, :]
        y = y + kv * ssm_D[None, None, :]
        return q * y

    def _B_ref(x, Lambda_re, Lambda_im, B_re, B_im, C_re, C_im, log_dt, Dskip):
        Bsz, L, H = x.shape
        Lam = Lambda_re + 1j * Lambda_im
        Bmat = B_re + 1j * B_im
        Cmat = C_re + 1j * C_im
        dt = torch.exp(log_dt)
        Lam_bar = torch.exp(dt * Lam)
        B_bar = ((Lam_bar - 1.0) / Lam)[:, None] * Bmat
        Bu = torch.einsum("bld,pd->blp", x + 0j, B_bar)
        h = torch.zeros_like(Bu[:, 0, :])
        hs = []
        for t in range(L):
            h = Lam_bar[None, :] * h + Bu[:, t, :]
            hs.append(h)
        hseq = torch.stack(hs, 1)
        y = 2.0 * torch.einsum("blp,dp->bld", hseq, Cmat).real + x * Dskip[None, None, :]
        return y

    a = _A_ref(A_q, A_k, A_v, A_shift_k, A_ssm_k, A_ssm_D)
    b = _B_ref(B_x, B_Lambda_re, B_Lambda_im, B_B_re, B_B_im, B_C_re, B_C_im, B_log_dt, B_Dskip)
    return torch.concatenate([a, b], axis=-1)
```

```asm
; @launch grid=(256,1,1) block=(512,1,1) lds=163840
.amdgcn_target "amdgcn-amd-amdhsa--gfx950"
.text
.globl concat_heads__ssm_conv_h3__ssm_conv_s5__prompt_kernel
.p2align 8
.type concat_heads__ssm_conv_h3__ssm_conv_s5__prompt_kernel,@function
concat_heads__ssm_conv_h3__ssm_conv_s5__prompt_kernel:
    s_cmp_ge_u32 s2, 256
    s_cbranch_scc1 L_exit
    s_load_dwordx16 s[16:31], s[0:1], 0
    s_load_dwordx16 s[32:47], s[0:1], 64
    s_load_dwordx4 s[48:51], s[0:1], 128
    s_memrealtime s[98:99]
    s_and_b32 s4, s2, 7
    s_lshr_b32 s5, s2, 3
    v_lshrrev_b32 v1, 6, v0
    v_and_b32 v0, 63, v0
    v_readfirstlane_b32 s3, v1
    s_cmp_lt_u32 s5, 20
    s_cbranch_scc1 L_roleB
    s_getpc_b64 s[6:7]
    s_and_b32 s6, s6, 0xffffff00
    s_cmp_ge_u32 s3, 4
    s_cbranch_scc1 L_nocpf
    s_cmp_lg_u32 s5, 30
    s_cbranch_scc1 L_nocpf
    s_lshl_b32 s8, s3, 13
    v_lshl_add_u32 v2, v0, 7, s8
    v_min_u32 v2, L_exit-concat_heads__ssm_conv_h3__ssm_conv_s5__prompt_kernel, v2
    global_load_dword v255, v2, s[6:7]
L_nocpf:
    s_cmp_ge_u32 s5, 30
    s_cbranch_scc1 L_roleP
    s_sub_u32 s12, s5, 20
    s_mul_i32 s13, s3, 10
    s_add_u32 s12, s12, s13
    s_cmp_ge_u32 s12, 72
    s_cbranch_scc1 Lhelp2_1
    v_and_b32 v253, 15, v0
    v_mul_u32_u24 v253, 1280, v253
    v_lshrrev_b32 v254, 4, v0
    v_lshl_add_u32 v253, v254, 7, v253
    s_and_b32 s13, s4, 1
    s_mul_i32 s13, s13, 20
    s_add_u32 s13, s13, s12
    s_sub_u32 s13, s13, 32
    s_sub_u32 s14, s13, 20
    s_lshr_b32 s15, s4, 1
    s_lshl_b32 s15, s15, 5
    s_add_u32 s15, s15, s12
    s_mov_b32 s62, 819200
    s_mov_b32 s63, 0x20000
    s_mov_b64 exec, 4294967295
    s_waitcnt lgkmcnt(0)
    s_cmp_ge_u32 s12, 52
    s_cselect_b32 s60, s36, s34
    s_cselect_b32 s61, s37, s35
    s_cselect_b32 s13, s14, s13
    s_cmp_lt_u32 s12, 32
    s_cselect_b32 s60, s28, s60
    s_cselect_b32 s61, s29, s61
    s_cselect_b32 s62, 2621440, s62
    s_cselect_b32 s13, s15, s13
    s_mul_i32 s13, s13, 20480
    buffer_load_dword v254, v253, s[60:63], s13 offen offset:256
    buffer_load_dword v254, v253, s[60:63], s13 offen offset:512
    buffer_load_dword v254, v253, s[60:63], s13 offen offset:768
    buffer_load_dword v254, v253, s[60:63], s13 offen offset:1024
    s_mov_b64 exec, -1
Lhelp2_1:
    s_branch L_roleA
L_roleB:
    s_mul_i32 s6, s5, 52
    s_lshr_b32 s6, s6, 8
    s_mul_i32 s13, s6, 5
    s_sub_u32 s14, s5, s13
    s_lshr_b32 s8, s4, 1
    s_lshl_b32 s8, s8, 2
    s_add_u32 s8, s8, s6
    s_and_b32 s9, s4, 1
    s_mul_i32 s9, s9, 5
    s_add_u32 s9, s9, s14
    s_and_b32 s64, s3, 3
    s_lshr_b32 s65, s3, 2
    s_lshl_b32 s82, s3, 12
    s_add_u32 s13, s6, s14
    s_lshl_b32 s13, s13, 2
    s_lshr_b32 s13, 0x10101010, s13
    s_and_b32 s13, s13, 15
    s_mov_b32 s62, 0x76543210
    s_mov_b32 s63, 0x98
    s_cmp_eq_u32 s13, 1
    s_cselect_b32 s62, 0x67452301, s62
    s_cselect_b32 s63, 0x89, s63
    v_lshrrev_b32 v43, 5, v0
    v_bfe_u32 v2, v0, 3, 2
    v_lshl_add_u32 v1, v43, 4, v2
    v_lshrrev_b32 v2, 3, v0
    s_lshl_b32 s13, s8, 2
    s_add_u32 s13, s13, s3
    s_lshl_b32 s14, s9, 1
    s_and_b32 s15, s3, 1
    s_add_u32 s14, s14, s15
    s_cmp_lt_u32 s3, 4
    s_cselect_b32 s13, s13, s14
    s_cselect_b64 vcc, -1, 0
    s_movk_i32 s66, 9216
    s_cselect_b32 s66, 4096, s66
    s_lshl_b32 s13, s13, 5
    s_lshl_b32 s67, s66, 1
    v_cndmask_b32 v1, v2, v1, vcc
    v_add_u32 v1, s13, v1
    v_mul_u32_u24 v1, 1280, v1
    v_and_b32 v3, 7, v0
    v_lshrrev_b32 v4, 4, v0
    v_xor_b32 v3, v3, v4
    v_lshlrev_b32 v3, 4, v3
    v_xor_b32 v4, 64, v3
    v_add_u32 v16, v1, v3
    v_add3_u32 v17, v1, v4, s66
    v_add_u32 v18, s67, v16
    v_add_u32 v19, s67, v17
    v_and_b32 v42, 31, v0
    s_lshl_b32 s13, s9, 1
    s_add_u32 s13, s13, s65
    s_lshl_b32 s13, s13, 5
    v_add_lshl_u32 v5, v42, s13, 1
    s_mov_b32 s54, 819200
    s_mov_b32 s55, 0x20000
    s_waitcnt lgkmcnt(0)
    s_cmp_ge_u32 s3, 6
    s_cselect_b32 s52, s36, s34
    s_cselect_b32 s53, s37, s35
    s_cmp_lt_u32 s3, 4
    s_cselect_b32 s52, s28, s52
    s_cselect_b32 s53, s29, s53
    s_cselect_b32 s54, 2621440, s54
    s_bfe_u32 s12, s62, 0x40000
    s_lshl_b32 s12, s12, 7
    s_add_u32 m0, s82, 0
    s_nop 0
    buffer_load_dwordx4 v16, s[52:55], s12 offen offset:0 lds
    buffer_load_dwordx4 v17, s[52:55], s12 offen offset:1024 lds
    buffer_load_dwordx4 v18, s[52:55], s12 offen offset:2048 lds
    buffer_load_dwordx4 v19, s[52:55], s12 offen offset:3072 lds
    s_bfe_u32 s12, s62, 0x40004
    s_lshl_b32 s12, s12, 7
    s_add_u32 m0, s82, 32768
    s_nop 0
    buffer_load_dwordx4 v16, s[52:55], s12 offen offset:0 lds
    buffer_load_dwordx4 v17, s[52:55], s12 offen offset:1024 lds
    buffer_load_dwordx4 v18, s[52:55], s12 offen offset:2048 lds
    buffer_load_dwordx4 v19, s[52:55], s12 offen offset:3072 lds
    global_load_ushort v46, v5, s[30:31]
    global_load_ushort v47, v5, s[32:33]
    global_load_ushort v44, v5, s[42:43]
    s_mov_b32 s76, s48
    s_mov_b32 s77, s49
    s_mov_b32 s78, 0x100
    s_mov_b32 s79, 0x20000
    v_mov_b32 v40, 0
    s_or_b32 s13, s5, s3
    s_cmp_lg_u32 s13, 0
    s_cbranch_scc1 Lnon_2
    s_or_b32 s14, s98, 1
    v_mov_b32 v6, s14
    v_mov_b32 v7, 0
    s_mov_b64 exec, 1
    buffer_atomic_cmpswap v[6:7], v40, s[76:79], 0 offen sc1
    s_mov_b64 exec, -1
Lnon_2:
    v_bfe_u32 v2, v0, 1, 3
    v_xor_b32 v1, v43, v2
    v_lshlrev_b32 v1, 4, v1
    v_lshl_add_u32 v41, v42, 7, v1
    s_lshl_b32 s13, s64, 12
    s_lshl_b32 s14, s65, 12
    s_add_u32 s14, s14, 16384
    v_add_u32 v96, s13, v41
    v_add_u32 v104, s14, v41
    v_xor_b32 v97, 32, v96
    v_xor_b32 v105, 32, v104
    v_xor_b32 v98, 64, v96
    v_xor_b32 v106, 64, v104
    v_xor_b32 v99, 96, v96
    v_xor_b32 v107, 96, v104
    v_add_u32 v100, 0x10000, v96
    v_add_u32 v108, 0x10000, v104
    v_add_u32 v101, 0x10000, v97
    v_add_u32 v109, 0x10000, v105
    v_add_u32 v102, 0x10000, v98
    v_add_u32 v110, 0x10000, v106
    v_add_u32 v103, 0x10000, v99
    v_add_u32 v111, 0x10000, v107
    s_mul_i32 s13, s6, 4
    s_sub_u32 s13, s5, s13
    s_sub_u32 s14, s13, 5
    s_cmp_ge_u32 s13, 5
    s_cselect_b32 s13, s14, s13
    s_and_b32 s15, s4, 1
    s_mul_i32 s7, s15, 3
    s_and_b32 s14, s13, 1
    s_add_u32 s7, s7, s14
    s_lshr_b32 s14, s13, 1
    s_cmp_eq_u32 s13, 4
    s_cselect_b32 s7, 2, s7
    s_cselect_b32 s14, s15, s14
    s_lshl_b32 s10, s8, 1
    s_add_u32 s10, s10, s14
    s_mov_b32 s11, s9
    s_sub_u32 s13, s11, 10
    s_cmp_ge_u32 s11, 10
    s_cselect_b32 s11, s13, s11
    s_lshl_b32 s83, s11, 7
    s_cmp_ge_u32 s3, 4
    s_cselect_b32 s56, s40, s38
    s_cselect_b32 s57, s41, s39
    s_mov_b32 s58, 819200
    s_mov_b32 s59, 0x20000
    s_lshl_b32 s13, s7, 7
    s_lshl_b32 s14, s64, 5
    s_add_u32 s13, s13, s14
    v_lshrrev_b32 v1, 3, v0
    v_add_u32 v1, s13, v1
    v_mul_u32_u24 v1, 1280, v1
    v_add_u32 v60, v1, v3
    v_add_u32 v61, v1, v4
    v_add_u32 v61, 9216, v61
    v_add_u32 v62, 18432, v60
    v_add_u32 v63, 18432, v61
    s_lshl_b32 s13, s64, 1
    v_add_u32 v48, s13, v43
    s_mul_i32 s13, s65, 4608
    s_add_u32 s13, s13, 0x20000
    v_mul_u32_u24 v57, 144, v42
    v_add_u32 v57, s13, v57
    v_lshl_add_u32 v56, v48, 4, v57
    s_lshl_b32 s13, s9, 14
    s_lshl_b32 s14, s65, 9
    s_add_u32 s13, s13, s14
    s_add_u32 s13, s13, 0xa00000
    v_lshl_add_u32 v49, v42, 4, s13
    s_mov_b32 s24, s28
    s_mov_b32 s25, s29
    s_mov_b32 s26, 0x280000
    s_mov_b32 s27, 0x20000
    s_lshl_b32 s18, s3, 11
    s_add_u32 s18, s18, 0x23000
    v_lshlrev_b32 v59, 6, v42
    v_lshl_add_u32 v59, v43, 4, v59
    v_add_u32 v59, s18, v59
    s_lshl_b32 s13, s10, 6
    s_lshl_b32 s14, s65, 5
    s_add_u32 s13, s13, s14
    v_lshrrev_b32 v14, 2, v0
    v_add_u32 v14, s13, v14
    v_mul_u32_u24 v14, 1280, v14
    v_and_b32 v15, 3, v0
    v_lshl_add_u32 v14, v15, 4, v14
    s_lshl_b32 s13, s7, 8
    s_lshl_b32 s14, s64, 6
    s_add_u32 s13, s13, s14
    v_add_u32 v14, s13, v14
    s_movk_i32 s19, 19456
    v_lshl_add_u32 v15, v42, 1, s13
    s_mov_b32 s68, s50
    s_mov_b32 s69, s51
    s_mov_b32 s70, 0x10000000
    s_mov_b32 s71, 0x20000
    s_waitcnt vmcnt(7)
    s_barrier
    ds_read_b128 v[208:211], v96 offset:0
    ds_read_b128 v[212:215], v104 offset:0
    ds_read_b128 v[216:219], v104 offset:8192
    ds_read_b128 v[220:223], v97 offset:0
    ds_read_b128 v[224:227], v105 offset:0
    ds_read_b128 v[228:231], v105 offset:8192
    s_bfe_u32 s12, s62, 0x40008
    s_lshl_b32 s12, s12, 7
    s_add_u32 m0, s82, 65536
    s_nop 0
    buffer_load_dwordx4 v16, s[52:55], s12 offen offset:0 lds
    buffer_load_dwordx4 v17, s[52:55], s12 offen offset:1024 lds
    s_waitcnt lgkmcnt(0)
    v_mfma_f32_32x32x16_bf16 v[64:79], v[208:211], v[212:215], 0
    ds_read_b128 v[232:235], v98 offset:0
    ds_read_b128 v[236:239], v106 offset:0
    buffer_load_dwordx4 v18, s[52:55], s12 offen offset:2048 lds
    v_mfma_f32_32x32x16_bf16 v[80:95], v[208:211], v[216:219], 0
    ds_read_b128 v[240:243], v106 offset:8192
    ds_read_b128 v[244:247], v99 offset:0
    buffer_load_dwordx4 v19, s[52:55], s12 offen offset:3072 lds
    v_mfma_f32_32x32x16_bf16 v[64:79], v[220:223], v[224:227], v[64:79]
    ds_read_b128 v[248:251], v107 offset:0
    ds_read_b128 v[252:255], v107 offset:8192
    s_waitcnt vmcnt(7)
    s_barrier
    v_mfma_f32_32x32x16_bf16 v[80:95], v[220:223], v[228:231], v[80:95]
    s_bfe_u32 s12, s62, 0x4000c
    s_lshl_b32 s12, s12, 7
    s_add_u32 m0, s82, 98304
    s_nop 0
    buffer_load_dwordx4 v16, s[52:55], s12 offen offset:0 lds
    s_waitcnt lgkmcnt(0)
    v_mfma_f32_32x32x16_bf16 v[64:79], v[232:235], v[236:239], v[64:79]
    ds_read_b128 v[208:211], v96 offset:32768
    ds_read_b128 v[212:215], v104 offset:32768
    buffer_load_dwordx4 v17, s[52:55], s12 offen offset:1024 lds
    v_mfma_f32_32x32x16_bf16 v[80:95], v[232:235], v[240:243], v[80:95]
    ds_read_b128 v[216:219], v104 offset:40960
    ds_read_b128 v[220:223], v97 offset:32768
    buffer_load_dwordx4 v18, s[52:55], s12 offen offset:2048 lds
    v_mfma_f32_32x32x16_bf16 v[64:79], v[244:247], v[248:251], v[64:79]
    ds_read_b128 v[224:227], v105 offset:32768
    ds_read_b128 v[228:231], v105 offset:40960
    v_mfma_f32_32x32x16_bf16 v[80:95], v[244:247], v[252:255], v[80:95]
    buffer_load_dwordx4 v19, s[52:55], s12 offen offset:3072 lds
    s_waitcnt lgkmcnt(0)
    v_mfma_f32_32x32x16_bf16 v[64:79], v[208:211], v[212:215], v[64:79]
    ds_read_b128 v[232:235], v98 offset:32768
    ds_read_b128 v[236:239], v106 offset:32768
    v_mfma_f32_32x32x16_bf16 v[80:95], v[208:211], v[216:219], v[80:95]
    ds_read_b128 v[240:243], v106 offset:40960
    ds_read_b128 v[244:247], v99 offset:32768
    v_mfma_f32_32x32x16_bf16 v[64:79], v[220:223], v[224:227], v[64:79]
    ds_read_b128 v[248:251], v107 offset:32768
    ds_read_b128 v[252:255], v107 offset:40960
    s_waitcnt vmcnt(4)
    s_barrier
    v_mfma_f32_32x32x16_bf16 v[80:95], v[220:223], v[228:231], v[80:95]
    s_bfe_u32 s12, s62, 0x40010
    s_lshl_b32 s12, s12, 7
    s_add_u32 m0, s82, 0
    s_nop 0
    buffer_load_dwordx4 v16, s[52:55], s12 offen offset:0 lds
    s_waitcnt lgkmcnt(0)
    v_mfma_f32_32x32x16_bf16 v[64:79], v[232:235], v[236:239], v[64:79]
    ds_read_b128 v[208:211], v100 offset:0
    ds_read_b128 v[212:215], v108 offset:0
    v_mfma_f32_32x32x16_bf16 v[80:95], v[232:235], v[240:243], v[80:95]
    ds_read_b128 v[216:219], v108 offset:8192
    ds_read_b128 v[220:223], v101 offset:0
    buffer_load_dwordx4 v17, s[52:55], s12 offen offset:1024 lds
    v_mfma_f32_32x32x16_bf16 v[64:79], v[244:247], v[248:251], v[64:79]
    ds_read_b128 v[224:227], v109 offset:0
    ds_read_b128 v[228:231], v109 offset:8192
    v_mfma_f32_32x32x16_bf16 v[80:95], v[244:247], v[252:255], v[80:95]
    buffer_load_dwordx4 v18, s[52:55], s12 offen offset:2048 lds
    s_waitcnt lgkmcnt(0)
    v_mfma_f32_32x32x16_bf16 v[64:79], v[208:211], v[212:215], v[64:79]
    ds_read_b128 v[232:235], v102 offset:0
    ds_read_b128 v[236:239], v110 offset:0
    v_mfma_f32_32x32x16_bf16 v[80:95], v[208:211], v[216:219], v[80:95]
    ds_read_b128 v[240:243], v110 offset:8192
    ds_read_b128 v[244:247], v103 offset:0
    buffer_load_dwordx4 v19, s[52:55], s12 offen offset:3072 lds
    v_mfma_f32_32x32x16_bf16 v[64:79], v[220:223], v[224:227], v[64:79]
    ds_read_b128 v[248:251], v111 offset:0
    ds_read_b128 v[252:255], v111 offset:8192
    s_waitcnt vmcnt(4)
    s_barrier
    v_mfma_f32_32x32x16_bf16 v[80:95], v[220:223], v[228:231], v[80:95]
    buffer_load_dword v39, v40, s[76:79], 0 offen sc1
    s_bfe_u32 s12, s62, 0x40014
    s_lshl_b32 s12, s12, 7
    s_add_u32 m0, s82, 32768
    s_nop 0
    buffer_load_dwordx4 v16, s[52:55], s12 offen offset:0 lds
    s_waitcnt lgkmcnt(0)
    v_mfma_f32_32x32x16_bf16 v[64:79], v[232:235], v[236:239], v[64:79]
    ds_read_b128 v[208:211], v100 offset:32768
    ds_read_b128 v[212:215], v108 offset:32768
    v_mfma_f32_32x32x16_bf16 v[80:95], v[232:235], v[240:243], v[80:95]
    ds_read_b128 v[216:219], v108 offset:40960
    ds_read_b128 v[220:223], v101 offset:32768
    buffer_load_dwordx4 v17, s[52:55], s12 offen offset:1024 lds
    v_mfma_f32_32x32x16_bf16 v[64:79], v[244:247], v[248:251], v[64:79]
    ds_read_b128 v[224:227], v109 offset:32768
    ds_read_b128 v[228:231], v109 offset:40960
    v_mfma_f32_32x32x16_bf16 v[80:95], v[244:247], v[252:255], v[80:95]
    buffer_load_dwordx4 v18, s[52:55], s12 offen offset:2048 lds
    s_waitcnt lgkmcnt(0)
    v_mfma_f32_32x32x16_bf16 v[64:79], v[208:211], v[212:215], v[64:79]
    ds_read_b128 v[232:235], v102 offset:32768
    ds_read_b128 v[236:239], v110 offset:32768
    v_mfma_f32_32x32x16_bf16 v[80:95], v[208:211], v[216:219], v[80:95]
    ds_read_b128 v[240:243], v110 offset:40960
    ds_read_b128 v[244:247], v103 offset:32768
    buffer_load_dwordx4 v19, s[52:55], s12 offen offset:3072 lds
    v_mfma_f32_32x32x16_bf16 v[64:79], v[220:223], v[224:227], v[64:79]
    ds_read_b128 v[248:251], v111 offset:32768
    ds_read_b128 v[252:255], v111 offset:40960
    s_waitcnt vmcnt(5)
    s_barrier
    v_mfma_f32_32x32x16_bf16 v[80:95], v[220:223], v[228:231], v[80:95]
    s_bfe_u32 s12, s62, 0x40018
    s_lshl_b32 s12, s12, 7
    s_add_u32 m0, s82, 65536
    s_nop 0
    buffer_load_dwordx4 v16, s[52:55], s12 offen offset:0 lds
    s_waitcnt lgkmcnt(0)
    v_mfma_f32_32x32x16_bf16 v[64:79], v[232:235], v[236:239], v[64:79]
    ds_read_b128 v[208:211], v96 offset:0
    ds_read_b128 v[212:215], v104 offset:0
    v_mfma_f32_32x32x16_bf16 v[80:95], v[232:235], v[240:243], v[80:95]
    ds_read_b128 v[216:219], v104 offset:8192
    ds_read_b128 v[220:223], v97 offset:0
    buffer_load_dwordx4 v17, s[52:55], s12 offen offset:1024 lds
    v_mfma_f32_32x32x16_bf16 v[64:79], v[244:247], v[248:251], v[64:79]
    ds_read_b128 v[224:227], v105 offset:0
    ds_read_b128 v[228:231], v105 offset:8192
    v_mfma_f32_32x32x16_bf16 v[80:95], v[244:247], v[252:255], v[80:95]
    buffer_load_dwordx4 v18, s[52:55], s12 offen offset:2048 lds
    s_waitcnt lgkmcnt(0)
    v_mfma_f32_32x32x16_bf16 v[64:79], v[208:211], v[212:215], v[64:79]
    ds_read_b128 v[232:235], v98 offset:0
    ds_read_b128 v[236:239], v106 offset:0
    v_mfma_f32_32x32x16_bf16 v[80:95], v[208:211], v[216:219], v[80:95]
    ds_read_b128 v[240:243], v106 offset:8192
    ds_read_b128 v[244:247], v99 offset:0
    buffer_load_dwordx4 v19, s[52:55], s12 offen offset:3072 lds
    v_mfma_f32_32x32x16_bf16 v[64:79], v[220:223], v[224:227], v[64:79]
    ds_read_b128 v[248:251], v107 offset:0
    ds_read_b128 v[252:255], v107 offset:8192
    s_waitcnt vmcnt(4)
    s_barrier
    v_mfma_f32_32x32x16_bf16 v[80:95], v[220:223], v[228:231], v[80:95]
    s_bfe_u32 s12, s62, 0x4001c
    s_lshl_b32 s12, s12, 7
    s_add_u32 m0, s82, 98304
    s_nop 0
    buffer_load_dwordx4 v16, s[52:55], s12 offen offset:0 lds
    s_waitcnt lgkmcnt(0)
    v_mfma_f32_32x32x16_bf16 v[64:79], v[232:235], v[236:239], v[64:79]
    ds_read_b128 v[208:211], v96 offset:32768
    ds_read_b128 v[212:215], v104 offset:32768
    v_mfma_f32_32x32x16_bf16 v[80:95], v[232:235], v[240:243], v[80:95]
    ds_read_b128 v[216:219], v104 offset:40960
    ds_read_b128 v[220:223], v97 offset:32768
    buffer_load_dwordx4 v17, s[52:55], s12 offen offset:1024 lds
    v_mfma_f32_32x32x16_bf16 v[64:79], v[244:247], v[248:251], v[64:79]
    ds_read_b128 v[224:227], v105 offset:32768
    ds_read_b128 v[228:231], v105 offset:40960
    v_mfma_f32_32x32x16_bf16 v[80:95], v[244:247], v[252:255], v[80:95]
    buffer_load_dwordx4 v18, s[52:55], s12 offen offset:2048 lds
    s_waitcnt lgkmcnt(0)
    v_mfma_f32_32x32x16_bf16 v[64:79], v[208:211], v[212:215], v[64:79]
    ds_read_b128 v[232:235], v98 offset:32768
    ds_read_b128 v[236:239], v106 offset:32768
    v_mfma_f32_32x32x16_bf16 v[80:95], v[208:211], v[216:219], v[80:95]
    ds_read_b128 v[240:243], v106 offset:40960
    ds_read_b128 v[244:247], v99 offset:32768
    buffer_load_dwordx4 v19, s[52:55], s12 offen offset:3072 lds
    v_mfma_f32_32x32x16_bf16 v[64:79], v[220:223], v[224:227], v[64:79]
    ds_read_b128 v[248:251], v107 offset:32768
    ds_read_b128 v[252:255], v107 offset:40960
    s_waitcnt vmcnt(4)
    s_barrier
    v_mfma_f32_32x32x16_bf16 v[80:95], v[220:223], v[228:231], v[80:95]
    s_bfe_u32 s12, s63, 0x40000
    s_lshl_b32 s12, s12, 7
    s_add_u32 m0, s82, 0
    s_nop 0
    buffer_load_dwordx4 v16, s[52:55], s12 offen offset:0 lds
    s_waitcnt lgkmcnt(0)
    v_mfma_f32_32x32x16_bf16 v[64:79], v[232:235], v[236:239], v[64:79]
    ds_read_b128 v[208:211], v100 offset:0
    ds_read_b128 v[212:215], v108 offset:0
    v_mfma_f32_32x32x16_bf16 v[80:95], v[232:235], v[240:243], v[80:95]
    ds_read_b128 v[216:219], v108 offset:8192
    ds_read_b128 v[220:223], v101 offset:0
    buffer_load_dwordx4 v17, s[52:55], s12 offen offset:1024 lds
    v_mfma_f32_32x32x16_bf16 v[64:79], v[244:247], v[248:251], v[64:79]
    ds_read_b128 v[224:227], v109 offset:0
    ds_read_b128 v[228:231], v109 offset:8192
    v_mfma_f32_32x32x16_bf16 v[80:95], v[244:247], v[252:255], v[80:95]
    buffer_load_dwordx4 v18, s[52:55], s12 offen offset:2048 lds
    s_waitcnt lgkmcnt(0)
    v_mfma_f32_32x32x16_bf16 v[64:79], v[208:211], v[212:215], v[64:79]
    ds_read_b128 v[232:235], v102 offset:0
    ds_read_b128 v[236:239], v110 offset:0
    v_mfma_f32_32x32x16_bf16 v[80:95], v[208:211], v[216:219], v[80:95]
    ds_read_b128 v[240:243], v110 offset:8192
    ds_read_b128 v[244:247], v103 offset:0
    buffer_load_dwordx4 v19, s[52:55], s12 offen offset:3072 lds
    v_mfma_f32_32x32x16_bf16 v[64:79], v[220:223], v[224:227], v[64:79]
    ds_read_b128 v[248:251], v111 offset:0
    ds_read_b128 v[252:255], v111 offset:8192
    s_waitcnt vmcnt(4)
    s_barrier
    v_mfma_f32_32x32x16_bf16 v[80:95], v[220:223], v[228:231], v[80:95]
    s_bfe_u32 s12, s63, 0x40004
    s_lshl_b32 s12, s12, 7
    s_add_u32 m0, s82, 32768
    s_nop 0
    buffer_load_dwordx4 v16, s[52:55], s12 offen offset:0 lds
    s_waitcnt lgkmcnt(0)
    v_mfma_f32_32x32x16_bf16 v[64:79], v[232:235], v[236:239], v[64:79]
    ds_read_b128 v[208:211], v100 offset:32768
    ds_read_b128 v[212:215], v108 offset:32768
    v_mfma_f32_32x32x16_bf16 v[80:95], v[232:235], v[240:243], v[80:95]
    ds_read_b128 v[216:219], v108 offset:40960
    ds_read_b128 v[220:223], v101 offset:32768
    buffer_load_dwordx4 v17, s[52:55], s12 offen offset:1024 lds
    v_mfma_f32_32x32x16_bf16 v[64:79], v[244:247], v[248:251], v[64:79]
    ds_read_b128 v[224:227], v109 offset:32768
    ds_read_b128 v[228:231], v109 offset:40960
    v_mfma_f32_32x32x16_bf16 v[80:95], v[244:247], v[252:255], v[80:95]
    buffer_load_dwordx4 v18, s[52:55], s12 offen offset:2048 lds
    s_waitcnt lgkmcnt(0)
    v_mfma_f32_32x32x16_bf16 v[64:79], v[208:211], v[212:215], v[64:79]
    ds_read_b128 v[232:235], v102 offset:32768
    ds_read_b128 v[236:239], v110 offset:32768
    v_lshlrev_b32 v46, 16, v46
    v_lshlrev_b32 v47, 16, v47
    v_mfma_f32_32x32x16_bf16 v[80:95], v[208:211], v[216:219], v[80:95]
    ds_read_b128 v[240:243], v110 offset:40960
    ds_read_b128 v[244:247], v103 offset:32768
    v_lshlrev_b32 v10, 16, v44
    v_mul_f32 v10, 0x3fb8aa3b, v10
    buffer_load_dwordx4 v19, s[52:55], s12 offen offset:3072 lds
    v_mfma_f32_32x32x16_bf16 v[64:79], v[220:223], v[224:227], v[64:79]
    ds_read_b128 v[248:251], v111 offset:32768
    ds_read_b128 v[252:255], v111 offset:40960
    s_waitcnt vmcnt(4)
    s_barrier
    v_exp_f32 v10, v10
    s_nop 0
    v_cvt_pk_bf16_f32 v10, v10, v10
    v_mfma_f32_32x32x16_bf16 v[80:95], v[220:223], v[228:231], v[80:95]
    v_lshlrev_b32 v10, 16, v10
    v_mul_f32 v44, v10, v46
    s_mov_b32 m0, s18
    s_nop 0
    buffer_load_dwordx4 v14, s[24:27], 0 offen lds
    global_load_ushort v58, v15, s[44:45]
    s_waitcnt lgkmcnt(0)
    v_mfma_f32_32x32x16_bf16 v[64:79], v[232:235], v[236:239], v[64:79]
    ds_read_b128 v[208:211], v96 offset:0
    ds_read_b128 v[212:215], v104 offset:0
    v_mul_f32 v45, v10, v47
    v_mul_f32 v44, 0x3fb8aa3b, v44
    buffer_load_dwordx4 v14, s[24:27], s19 offen offset:1024 lds
    v_mfma_f32_32x32x16_bf16 v[80:95], v[232:235], v[240:243], v[80:95]
    ds_read_b128 v[216:219], v104 offset:8192
    ds_read_b128 v[220:223], v97 offset:0
    v_mul_f32 v45, 0.15915494, v45
    v_lshlrev_b32 v13, 4, v48
    s_add_u32 m0, s82, 65536
    s_nop 0
    buffer_load_dwordx4 v60, s[56:59], s83 offen offset:0 lds
    v_mfma_f32_32x32x16_bf16 v[64:79], v[244:247], v[248:251], v[64:79]
    ds_read_b128 v[224:227], v105 offset:0
    ds_read_b128 v[228:231], v105 offset:8192
    v_cvt_f32_u32 v13, v13
    v_sub_f32 v13, 0x42e00000, v13
    v_mfma_f32_32x32x16_bf16 v[80:95], v[244:247], v[252:255], v[80:95]
    v_mul_f32 v11, 1.0, v44
    v_mul_f32 v12, 1.0, v45
    buffer_load_dwordx4 v61, s[56:59], s83 offen offset:1024 lds
    s_waitcnt lgkmcnt(0)
    v_mfma_f32_32x32x16_bf16 v[64:79], v[208:211], v[212:215], v[64:79]
    ds_read_b128 v[232:235], v98 offset:0
    ds_read_b128 v[236:239], v106 offset:0
    v_exp_f32 v11, v11
    v_fract_f32 v12, v12
    buffer_load_dwordx4 v62, s[56:59], s83 offen offset:2048 lds
    v_mfma_f32_32x32x16_bf16 v[80:95], v[208:211], v[216:219], v[80:95]
    ds_read_b128 v[240:243], v106 offset:8192
    ds_read_b128 v[244:247], v99 offset:0
    v_cos_f32 v28, v12
    v_sin_f32 v29, v12
    buffer_load_dwordx4 v63, s[56:59], s83 offen offset:3072 lds
    s_add_u32 s83, s83, 384
    s_cmp_ge_u32 s83, 1280
    s_cselect_b32 s66, 1280, 0
    s_sub_u32 s83, s83, s66
    v_mfma_f32_32x32x16_bf16 v[64:79], v[220:223], v[224:227], v[64:79]
    ds_read_b128 v[248:251], v107 offset:0
    ds_read_b128 v[252:255], v107 offset:8192
    s_waitcnt vmcnt(7)
    s_barrier
    v_mul_f32 v28, v11, v28
    v_mul_f32 v29, v11, v29
    v_mfma_f32_32x32x16_bf16 v[80:95], v[220:223], v[228:231], v[80:95]
    v_sub_f32 v30, 0, v29
    v_mul_f32 v11, v13, v44
    s_add_u32 m0, s82, 98304
    s_nop 0
    buffer_load_dwordx4 v60, s[56:59], s83 offen offset:0 lds
    s_waitcnt lgkmcnt(0)
    v_mfma_f32_32x32x16_bf16 v[64:79], v[232:235], v[236:239], v[64:79]
    ds_read_b128 v[208:211], v96 offset:32768
    ds_read_b128 v[212:215], v104 offset:32768
    v_mul_f32 v12, v13, v45
    v_exp_f32 v11, v11
    buffer_load_dwordx4 v61, s[56:59], s83 offen offset:1024 lds
    v_mfma_f32_32x32x16_bf16 v[80:95], v[232:235], v[240:243], v[80:95]
    ds_read_b128 v[216:219], v104 offset:40960
    ds_read_b128 v[220:223], v97 offset:32768
    v_fract_f32 v12, v12
    v_cos_f32 v35, v12
    buffer_load_dwordx4 v62, s[56:59], s83 offen offset:2048 lds
    v_mfma_f32_32x32x16_bf16 v[64:79], v[244:247], v[248:251], v[64:79]
    ds_read_b128 v[224:227], v105 offset:32768
    ds_read_b128 v[228:231], v105 offset:40960
    v_sin_f32 v36, v12
    v_mul_f32 v35, v11, v35
    v_mfma_f32_32x32x16_bf16 v[80:95], v[244:247], v[252:255], v[80:95]
    v_mul_f32 v36, v11, v36
    buffer_load_dwordx4 v63, s[56:59], s83 offen offset:3072 lds
    s_add_u32 s83, s83, 384
    s_cmp_ge_u32 s83, 1280
    s_cselect_b32 s66, 1280, 0
    s_sub_u32 s83, s83, s66
    s_waitcnt lgkmcnt(0)
    v_mfma_f32_32x32x16_bf16 v[64:79], v[208:211], v[212:215], v[64:79]
    ds_read_b128 v[232:235], v98 offset:32768
    ds_read_b128 v[236:239], v106 offset:32768
    v_mfma_f32_32x32x16_bf16 v[80:95], v[208:211], v[216:219], v[80:95]
    ds_read_b128 v[240:243], v106 offset:40960
    ds_read_b128 v[244:247], v99 offset:32768
    v_mfma_f32_32x32x16_bf16 v[64:79], v[220:223], v[224:227], v[64:79]
    ds_read_b128 v[248:251], v107 offset:32768
    ds_read_b128 v[252:255], v107 offset:40960
    v_mfma_f32_32x32x16_bf16 v[80:95], v[220:223], v[228:231], v[80:95]
    s_waitcnt lgkmcnt(0)
    v_mfma_f32_32x32x16_bf16 v[64:79], v[232:235], v[236:239], v[64:79]
    v_mfma_f32_32x32x16_bf16 v[80:95], v[232:235], v[240:243], v[80:95]
    v_mfma_f32_32x32x16_bf16 v[64:79], v[244:247], v[248:251], v[64:79]
    v_mfma_f32_32x32x16_bf16 v[80:95], v[244:247], v[252:255], v[80:95]
    s_mov_b32 s15, 20000
Ltag_3:
    v_cmp_eq_u32 vcc, 0, v39
    s_cbranch_vccz Ltagd_4
    buffer_load_dword v39, v40, s[76:79], 0 offen sc1
    s_waitcnt vmcnt(0)
    s_sub_u32 s15, s15, 1
    s_cmp_lg_u32 s15, 0
    s_cbranch_scc1 Ltag_3
Ltagd_4:
    s_nop 8
    v_fma_f32 v8, v30, v80, v65
    v_fma_f32 v9, v29, v64, v81
    v_fmac_f32 v8, v28, v64
    v_fmac_f32 v9, v28, v80
    v_fma_f32 v12, v30, v9, v66
    v_fma_f32 v13, v29, v8, v82
    v_fmac_f32 v12, v28, v8
    v_fmac_f32 v13, v28, v9
    v_fma_f32 v8, v30, v13, v67
    v_fma_f32 v9, v29, v12, v83
    v_fmac_f32 v8, v28, v12
    v_fmac_f32 v9, v28, v13
    v_fma_f32 v12, v30, v9, v68
    v_fma_f32 v13, v29, v8, v84
    v_fmac_f32 v12, v28, v8
    v_fmac_f32 v13, v28, v9
    v_fma_f32 v8, v30, v13, v69
    v_fma_f32 v9, v29, v12, v85
    v_fmac_f32 v8, v28, v12
    v_fmac_f32 v9, v28, v13
    v_fma_f32 v12, v30, v9, v70
    v_fma_f32 v13, v29, v8, v86
    v_fmac_f32 v12, v28, v8
    v_fmac_f32 v13, v28, v9
    v_fma_f32 v8, v30, v13, v71
    v_fma_f32 v9, v29, v12, v87
    v_fmac_f32 v8, v28, v12
    v_fmac_f32 v9, v28, v13
    v_fma_f32 v12, v30, v9, v72
    v_fma_f32 v13, v29, v8, v88
    v_fmac_f32 v12, v28, v8
    v_fmac_f32 v13, v28, v9
    v_fma_f32 v8, v30, v13, v73
    v_fma_f32 v9, v29, v12, v89
    v_fmac_f32 v8, v28, v12
    v_fmac_f32 v9, v28, v13
    v_fma_f32 v12, v30, v9, v74
    v_fma_f32 v13, v29, v8, v90
    v_fmac_f32 v12, v28, v8
    v_fmac_f32 v13, v28, v9
    v_fma_f32 v8, v30, v13, v75
    v_fma_f32 v9, v29, v12, v91
    v_fmac_f32 v8, v28, v12
    v_fmac_f32 v9, v28, v13
    v_fma_f32 v12, v30, v9, v76
    v_fma_f32 v13, v29, v8, v92
    v_fmac_f32 v12, v28, v8
    v_fmac_f32 v13, v28, v9
    v_fma_f32 v8, v30, v13, v77
    v_fma_f32 v9, v29, v12, v93
    v_fmac_f32 v8, v28, v12
    v_fmac_f32 v9, v28, v13
    v_fma_f32 v12, v30, v9, v78
    v_fma_f32 v13, v29, v8, v94
    v_fmac_f32 v12, v28, v8
    v_fmac_f32 v13, v28, v9
    v_fma_f32 v8, v30, v13, v79
    v_fma_f32 v9, v29, v12, v95
    v_fmac_f32 v8, v28, v12
    v_fmac_f32 v9, v28, v13
    v_mul_f32 v10, v8, v35
    v_mul_f32 v11, v8, v36
    v_fma_f32 v10, -v9, v36, v10
    v_fmac_f32 v11, v9, v35
    ds_write_b128 v56, v[8:11]
    s_waitcnt lgkmcnt(0)
    s_barrier
    ds_read_b128 v[208:211], v57 offset:0
    ds_read_b128 v[212:215], v57 offset:16
    ds_read_b128 v[216:219], v57 offset:32
    ds_read_b128 v[220:223], v57 offset:48
    ds_read_b128 v[224:227], v57 offset:64
    ds_read_b128 v[228:231], v57 offset:80
    ds_read_b128 v[232:235], v57 offset:96
    ds_read_b128 v[236:239], v57 offset:112
    s_cmp_lg_u32 s64, 0
    s_cbranch_scc1 Lpub_5
    s_lshl_b32 s13, s8, 10
    v_mov_b32 v9, v39
    v_mov_b32 v11, v39
    s_waitcnt lgkmcnt(0)
    v_add_f32 v8, v210, v214
    v_add_f32 v10, v211, v215
    v_add_f32 v1, v218, v222
    v_add_f32 v2, v219, v223
    v_add_f32 v12, v226, v230
    v_add_f32 v13, v227, v231
    v_add_f32 v5, v234, v238
    v_add_f32 v6, v235, v239
    v_add_f32 v8, v8, v1
    v_add_f32 v10, v10, v2
    v_add_f32 v12, v12, v5
    v_add_f32 v13, v13, v6
    v_add_f32 v8, v8, v12
    v_add_f32 v10, v10, v13
    s_mov_b32 exec_hi, 0
    buffer_store_dwordx4 v[8:11], v49, s[68:71], s13 offen sc1
    s_mov_b64 exec, -1
Lpub_5:
    v_add_u32 v20, s82, v41
    v_xor_b32 v21, 32, v20
    v_xor_b32 v22, 64, v20
    v_xor_b32 v23, 96, v20
    v_add_u32 v24, 0x10000, v20
    v_add_u32 v25, 0x10000, v21
    v_add_u32 v26, 0x10000, v22
    v_add_u32 v27, 0x10000, v23
    s_lshl_b32 s13, s64, 2
    s_sub_u32 s13, s8, s13
    s_sub_u32 s13, s13, 1
    v_sub_u32 v13, s13, v43
    v_mov_b32 v12, 0x80000000
    v_lshl_add_u32 v176, v13, 10, v49
    v_cmp_le_i32 vcc, 0, v13
    s_nop 1
    v_cndmask_b32 v176, v12, v176, vcc
    v_cndmask_b32 v184, 0, v39, vcc
    v_subrev_u32 v13, 2, v13
    v_lshl_add_u32 v177, v13, 10, v49
    v_cmp_le_i32 vcc, 0, v13
    s_nop 1
    v_cndmask_b32 v177, v12, v177, vcc
    v_cndmask_b32 v185, 0, v39, vcc
    v_add_f32 v1, -1.0, v28
    v_mul_f32 v2, v46, v46
    v_fmac_f32 v2, v47, v47
    v_rcp_f32 v2, v2
    v_mul_f32 v13, v1, v46
    v_fmac_f32 v13, v29, v47
    v_mul_f32 v14, v29, v46
    v_fma_f32 v14, -v1, v47, v14
    s_add_u32 m0, s82, 0
    s_nop 0
    buffer_load_dwordx4 v60, s[56:59], s83 offen offset:0 lds
    v_add_f32 v2, v2, v2
    v_mul_f32 v31, v13, v2
    v_mul_f32 v32, v14, v2
    v_lshlrev_b32 v13, 4, v48
    v_cvt_f32_u32 v13, v13
    v_mul_f32 v11, 0x41800000, v44
    v_mul_f32 v12, 0x41800000, v45
    v_exp_f32 v11, v11
    buffer_load_dwordx4 v61, s[56:59], s83 offen offset:1024 lds
    v_fract_f32 v12, v12
    v_cos_f32 v33, v12
    v_sin_f32 v34, v12
    v_mul_f32 v33, v11, v33
    v_mul_f32 v34, v11, v34
    v_mul_f32 v11, v13, v44
    v_mul_f32 v12, v13, v45
    v_exp_f32 v11, v11
    v_fract_f32 v12, v12
    v_cos_f32 v14, v12
    v_sin_f32 v15, v12
    v_mul_f32 v14, v11, v14
    v_mul_f32 v15, v11, v15
    v_mul_f32 v37, v14, v31
    v_mul_f32 v38, v14, v32
    v_fma_f32 v37, -v15, v32, v37
    buffer_load_dwordx4 v62, s[56:59], s83 offen offset:2048 lds
    v_fmac_f32 v38, v15, v31
    s_lshl_b32 s13, s64, 2
    v_add_u32 v15, s13, v43
    v_lshlrev_b32 v13, 7, v15
    v_cvt_f32_u32 v13, v13
    v_mul_f32 v11, v13, v44
    v_mul_f32 v12, v13, v45
    v_exp_f32 v11, v11
    v_fract_f32 v12, v12
    v_cos_f32 v52, v12
    v_sin_f32 v53, v12
    v_mul_f32 v52, v11, v52
    v_mul_f32 v53, v11, v53
    v_add_f32 v13, 0x43800000, v13
    v_mul_f32 v11, v13, v44
    v_mul_f32 v12, v13, v45
    buffer_load_dwordx4 v63, s[56:59], s83 offen offset:3072 lds
    s_add_u32 s83, s83, 384
    s_cmp_ge_u32 s83, 1280
    s_cselect_b32 s66, 1280, 0
    s_sub_u32 s83, s83, s66
    v_exp_f32 v11, v11
    v_fract_f32 v12, v12
    v_cos_f32 v50, v12
    v_sin_f32 v51, v12
    v_mul_f32 v50, v11, v50
    v_mul_f32 v51, v11, v51
    s_lshl_b32 s13, s65, 10
    s_add_u32 s13, s13, 0x22400
    v_lshl_add_u32 v57, v42, 5, s13
    s_lshl_b32 s13, s64, 3
    v_add_u32 v56, s13, v57
    s_waitcnt lgkmcnt(0)
    v_mov_b32 v14, 0
    v_mov_b32 v15, 0
    v_cmp_eq_u32 vcc, 1, v48
    s_nop 1
    v_cndmask_b32 v14, v14, v208, vcc
    s_add_u32 m0, s82, 32768
    s_nop 0
    buffer_load_dwordx4 v60, s[56:59], s83 offen offset:0 lds
    v_cndmask_b32 v15, v15, v209, vcc
    v_fma_f32 v1, v33, v208, v212
    v_fma_f32 v2, v33, v209, v213
    v_fma_f32 v1, -v34, v209, v1
    v_fmac_f32 v2, v34, v208
    v_cmp_eq_u32 vcc, 2, v48
    s_nop 1
    v_cndmask_b32 v14, v14, v1, vcc
    v_cndmask_b32 v15, v15, v2, vcc
    buffer_load_dwordx4 v61, s[56:59], s83 offen offset:1024 lds
    v_fma_f32 v5, v33, v1, v216
    v_fma_f32 v6, v33, v2, v217
    v_fma_f32 v5, -v34, v2, v5
    v_fmac_f32 v6, v34, v1
    v_cmp_eq_u32 vcc, 3, v48
    s_nop 1
    v_cndmask_b32 v14, v14, v5, vcc
    v_cndmask_b32 v15, v15, v6, vcc
    v_fma_f32 v1, v33, v5, v220
    v_fma_f32 v2, v33, v6, v221
    v_fma_f32 v1, -v34, v6, v1
    v_fmac_f32 v2, v34, v5
    v_cmp_eq_u32 vcc, 4, v48
    s_nop 1
    v_cndmask_b32 v14, v14, v1, vcc
    v_cndmask_b32 v15, v15, v2, vcc
    v_fma_f32 v5, v33, v1, v224
    v_fma_f32 v6, v33, v2, v225
    buffer_load_dwordx4 v62, s[56:59], s83 offen offset:2048 lds
    v_fma_f32 v5, -v34, v2, v5
    v_fmac_f32 v6, v34, v1
    v_cmp_eq_u32 vcc, 5, v48
    s_nop 1
    v_cndmask_b32 v14, v14, v5, vcc
    v_cndmask_b32 v15, v15, v6, vcc
    v_fma_f32 v1, v33, v5, v228
    v_fma_f32 v2, v33, v6, v229
    v_fma_f32 v1, -v34, v6, v1
    v_fmac_f32 v2, v34, v5
    v_cmp_eq_u32 vcc, 6, v48
    s_nop 1
    v_cndmask_b32 v14, v14, v1, vcc
    v_cndmask_b32 v15, v15, v2, vcc
    v_fma_f32 v5, v33, v1, v232
    v_fma_f32 v6, v33, v2, v233
    v_fma_f32 v5, -v34, v2, v5
    v_fmac_f32 v6, v34, v1
    buffer_load_dwordx4 v63, s[56:59], s83 offen offset:3072 lds
    s_add_u32 s83, s83, 384
    s_cmp_ge_u32 s83, 1280
    s_cselect_b32 s66, 1280, 0
    s_sub_u32 s83, s83, s66
    v_cmp_eq_u32 vcc, 7, v48
    s_nop 1
    v_cndmask_b32 v14, v14, v5, vcc
    v_cndmask_b32 v15, v15, v6, vcc
    v_mul_f32 v54, v14, v31
    v_mul_f32 v55, v14, v32
    v_fma_f32 v54, -v15, v32, v54
    v_fmac_f32 v55, v15, v31
    buffer_load_dwordx4 v[192:195], v176, s[68:71], 0 offen sc1
    buffer_load_dwordx4 v[196:199], v177, s[68:71], 0 offen sc1
    v_mul_f32 v6, v32, v80
    v_mul_f32 v80, v31, v80
    v_fmac_f32 v80, v32, v64
    v_fma_f32 v64, v31, v64, -v6
    v_mul_f32 v7, v32, v81
    v_mul_f32 v81, v31, v81
    v_fmac_f32 v81, v32, v65
    v_fma_f32 v65, v31, v65, -v7
    v_mul_f32 v6, v32, v82
    v_mul_f32 v82, v31, v82
    v_fmac_f32 v82, v32, v66
    v_fma_f32 v66, v31, v66, -v6
    v_mul_f32 v7, v32, v83
    v_mul_f32 v83, v31, v83
    v_fmac_f32 v83, v32, v67
    v_fma_f32 v67, v31, v67, -v7
    v_mul_f32 v6, v32, v84
    v_mul_f32 v84, v31, v84
    v_fmac_f32 v84, v32, v68
    v_fma_f32 v68, v31, v68, -v6
    v_mul_f32 v7, v32, v85
    v_mul_f32 v85, v31, v85
    v_fmac_f32 v85, v32, v69
    v_fma_f32 v69, v31, v69, -v7
    v_mul_f32 v6, v32, v86
    v_mul_f32 v86, v31, v86
    v_fmac_f32 v86, v32, v70
    v_fma_f32 v70, v31, v70, -v6
    v_mul_f32 v7, v32, v87
    v_mul_f32 v87, v31, v87
    v_fmac_f32 v87, v32, v71
    v_fma_f32 v71, v31, v71, -v7
    v_mul_f32 v6, v32, v88
    v_mul_f32 v88, v31, v88
    v_fmac_f32 v88, v32, v72
    v_fma_f32 v72, v31, v72, -v6
    v_mul_f32 v7, v32, v89
    v_mul_f32 v89, v31, v89
    v_fmac_f32 v89, v32, v73
    v_fma_f32 v73, v31, v73, -v7
    v_mul_f32 v6, v32, v90
    v_mul_f32 v90, v31, v90
    v_fmac_f32 v90, v32, v74
    v_fma_f32 v74, v31, v74, -v6
    v_mul_f32 v7, v32, v91
    v_mul_f32 v91, v31, v91
    v_fmac_f32 v91, v32, v75
    v_fma_f32 v75, v31, v75, -v7
    v_mul_f32 v6, v32, v92
    v_mul_f32 v92, v31, v92
    v_fmac_f32 v92, v32, v76
    v_fma_f32 v76, v31, v76, -v6
    v_mul_f32 v7, v32, v93
    v_mul_f32 v93, v31, v93
    v_fmac_f32 v93, v32, v77
    v_fma_f32 v77, v31, v77, -v7
    v_mul_f32 v6, v32, v94
    v_mul_f32 v94, v31, v94
    v_fmac_f32 v94, v32, v78
    v_fma_f32 v78, v31, v78, -v6
    v_mul_f32 v7, v32, v95
    v_mul_f32 v95, v31, v95
    v_fmac_f32 v95, v32, v79
    v_fma_f32 v79, v31, v79, -v7
    v_lshlrev_b32 v1, 4, v0
    v_and_b32 v2, 15, v0
    v_mul_u32_u24 v13, 24, v43
    v_xor_b32 v13, v13, v2
    v_lshlrev_b32 v13, 4, v13
    v_bfe_u32 v2, v0, 4, 1
    v_lshl_add_u32 v13, v2, 12, v13
    v_xor_b32 v14, 64, v13
    s_lshr_b32 s13, s64, 1
    s_lshl_b32 s14, s8, 1
    s_add_u32 s13, s13, s14
    s_mul_i32 s13, s13, 10
    s_add_u32 s13, s13, s9
    s_lshl_b32 s20, s13, 14
    s_lshl_b32 s13, s65, 13
    s_add_u32 s20, s20, s13
    s_and_b32 s13, s64, 1
    s_lshl_b32 s13, s13, 9
    s_add_u32 s20, s20, s13
    s_add_u32 s20, s20, 0x400000
    s_lshl_b32 s14, s8, 5
    s_add_u32 s14, s14, s9
    s_lshl_b32 s21, s14, 2
    s_add_u32 s21, s21, 0xb00000
    s_lshr_b32 s22, s10, 1
    s_lshl_b32 s22, s22, 7
    s_add_u32 s22, s22, 0xb00000
    s_mov_b32 s15, 20000
    s_waitcnt vmcnt(2)
    ds_read_b128 v[96:99], v24 offset:0
    ds_read_b128 v[100:103], v25 offset:0
    ds_read_b128 v[104:107], v26 offset:0
    ds_read_b128 v[108:111], v27 offset:0
    ds_read_b128 v[112:115], v24 offset:32768
    ds_read_b128 v[116:119], v25 offset:32768
    ds_read_b128 v[120:123], v26 offset:32768
    ds_read_b128 v[124:127], v27 offset:32768
    ds_read_b128 v[128:131], v20 offset:0
    ds_read_b128 v[132:135], v21 offset:0
    ds_read_b128 v[136:139], v22 offset:0
    ds_read_b128 v[140:143], v23 offset:0
    ds_read_b128 v[144:147], v20 offset:32768
    ds_read_b128 v[148:151], v21 offset:32768
    ds_read_b128 v[152:155], v22 offset:32768
    ds_read_b128 v[156:159], v23 offset:32768
    ds_read_b128 v[244:247], v59 offset:0
    ds_read_b128 v[248:251], v59 offset:32
    s_branch Lechk_7
Lepoll_6:
    buffer_load_dwordx4 v[192:195], v176, s[68:71], 0 offen sc1
    buffer_load_dwordx4 v[196:199], v177, s[68:71], 0 offen sc1
Lechk_7:
    s_waitcnt vmcnt(0)
    v_xor_b32 v8, v184, v193
    v_xor_b32 v9, v184, v195
    v_xor_b32 v10, v185, v197
    v_xor_b32 v11, v185, v199
    v_or3_b32 v8, v8, v9, v10
    v_or_b32 v8, v8, v11
    v_cmp_ne_u32 vcc, 0, v8
    s_cbranch_vccz Ledone_8
    s_sub_u32 s15, s15, 1
    s_cmp_lg_u32 s15, 0
    s_cbranch_scc1 Lepoll_6
Ledone_8:
    v_mul_f32 v10, v52, v192
    v_mul_f32 v11, v52, v194
    v_fma_f32 v10, -v53, v194, v10
    v_fmac_f32 v11, v53, v192
    v_fma_f32 v8, v50, v196, v10
    v_fma_f32 v9, v50, v198, v11
    v_fma_f32 v8, -v51, v198, v8
    v_fmac_f32 v9, v51, v196
    v_mov_b32 v10, v8
    v_mov_b32 v11, v9
    s_nop 0
    v_permlane32_swap_b32 v10, v8
    v_permlane32_swap_b32 v11, v9
    v_add_f32 v8, v8, v10
    v_add_f32 v9, v9, v11
    ds_write_b64 v56, v[8:9]
    s_waitcnt lgkmcnt(0)
    s_barrier
    ds_read_b128 v[192:195], v57
    ds_read_b128 v[196:199], v57 offset:16
    s_waitcnt lgkmcnt(0)
    v_add_f32 v8, v192, v194
    v_add_f32 v9, v193, v195
    v_add_f32 v10, v196, v198
    v_add_f32 v11, v197, v199
    v_add_f32 v8, v8, v10
    v_add_f32 v9, v9, v11
    v_fma_f32 v10, v37, v8, v54
    v_fma_f32 v11, v37, v9, v55
    v_fma_f32 v10, -v38, v9, v10
    v_fmac_f32 v11, v38, v8
    v_fmac_f32 v64, v30, v11
    v_fmac_f32 v80, v29, v10
    v_fmac_f32 v64, v28, v10
    v_fmac_f32 v80, v28, v11
    v_fmac_f32 v65, v30, v80
    v_fmac_f32 v81, v29, v64
    v_fmac_f32 v65, v28, v64
    v_fmac_f32 v81, v28, v80
    v_cvt_pk_bf16_f32 v224, v64, v65
    v_cvt_pk_bf16_f32 v232, -v80, -v81
    v_fmac_f32 v66, v30, v81
    v_fmac_f32 v82, v29, v65
    v_fmac_f32 v66, v28, v65
    v_fmac_f32 v82, v28, v81
    v_fmac_f32 v67, v30, v82
    v_fmac_f32 v83, v29, v66
    v_fmac_f32 v67, v28, v66
    v_fmac_f32 v83, v28, v82
    v_cvt_pk_bf16_f32 v225, v66, v67
    v_cvt_pk_bf16_f32 v233, -v82, -v83
    v_fmac_f32 v68, v30, v83
    v_fmac_f32 v84, v29, v67
    v_fmac_f32 v68, v28, v67
    v_fmac_f32 v84, v28, v83
    v_fmac_f32 v69, v30, v84
    v_fmac_f32 v85, v29, v68
    v_fmac_f32 v69, v28, v68
    v_fmac_f32 v85, v28, v84
    v_cvt_pk_bf16_f32 v226, v68, v69
    v_cvt_pk_bf16_f32 v234, -v84, -v85
    v_fmac_f32 v70, v30, v85
    v_fmac_f32 v86, v29, v69
    v_fmac_f32 v70, v28, v69
    v_fmac_f32 v86, v28, v85
    v_fmac_f32 v71, v30, v86
    v_fmac_f32 v87, v29, v70
    v_fmac_f32 v71, v28, v70
    v_fmac_f32 v87, v28, v86
    v_cvt_pk_bf16_f32 v227, v70, v71
    v_cvt_pk_bf16_f32 v235, -v86, -v87
    buffer_store_dwordx4 v[224:227], v13, s[68:71], s20 offen offset:0 sc1
    buffer_store_dwordx4 v[232:235], v13, s[68:71], s20 offen offset:2048 sc1
    v_fmac_f32 v72, v30, v87
    v_fmac_f32 v88, v29, v71
    v_fmac_f32 v72, v28, v71
    v_fmac_f32 v88, v28, v87
    v_fmac_f32 v73, v30, v88
    v_fmac_f32 v89, v29, v72
    v_fmac_f32 v73, v28, v72
    v_fmac_f32 v89, v28, v88
    v_cvt_pk_bf16_f32 v228, v72, v73
    v_cvt_pk_bf16_f32 v236, -v88, -v89
    v_fmac_f32 v74, v30, v89
    v_fmac_f32 v90, v29, v73
    v_fmac_f32 v74, v28, v73
    v_fmac_f32 v90, v28, v89
    v_fmac_f32 v75, v30, v90
    v_fmac_f32 v91, v29, v74
    v_fmac_f32 v75, v28, v74
    v_fmac_f32 v91, v28, v90
    v_cvt_pk_bf16_f32 v229, v74, v75
    v_cvt_pk_bf16_f32 v237, -v90, -v91
    v_fmac_f32 v76, v30, v91
    v_fmac_f32 v92, v29, v75
    v_fmac_f32 v76, v28, v75
    v_fmac_f32 v92, v28, v91
    v_fmac_f32 v77, v30, v92
    v_fmac_f32 v93, v29, v76
    v_fmac_f32 v77, v28, v76
    v_fmac_f32 v93, v28, v92
    v_cvt_pk_bf16_f32 v230, v76, v77
    v_cvt_pk_bf16_f32 v238, -v92, -v93
    v_fmac_f32 v78, v30, v93
    v_fmac_f32 v94, v29, v77
    v_fmac_f32 v78, v28, v77
    v_fmac_f32 v94, v28, v93
    v_fmac_f32 v79, v30, v94
    v_fmac_f32 v95, v29, v78
    v_fmac_f32 v79, v28, v78
    v_fmac_f32 v95, v28, v94
    v_cvt_pk_bf16_f32 v231, v78, v79
    v_cvt_pk_bf16_f32 v239, -v94, -v95
    buffer_store_dwordx4 v[228:231], v14, s[68:71], s20 offen offset:1024 sc1
    buffer_store_dwordx4 v[236:239], v14, s[68:71], s20 offen offset:3072 sc1
    s_waitcnt lgkmcnt(0)
    v_mov_b32 v16, v60
    v_mov_b32 v17, v61
    v_mov_b32 v18, v62
    v_mov_b32 v19, v63
    s_and_b32 s13, s20, 0x3fff
    s_add_u32 s13, s13, 65536
    v_add_u32 v28, s13, v13
    v_add_u32 v29, s13, v14
    v_and_b32 v7, 1, v0
    v_lshlrev_b32 v3, 4, v7
    v_lshlrev_b32 v3, v3, v58
    v_bfe_u32 v4, v0, 3, 1
    v_cmp_eq_u32 vcc, v4, v43
    s_nop 1
    v_cndmask_b32 v3, 0, v3, vcc
    s_add_u32 m0, s82, 0
    s_nop 0
    buffer_load_dwordx4 v16, s[56:59], s83 offen offset:0 lds
    v_bfe_u32 v4, v0, 1, 2
    v_bfe_u32 v6, v0, 4, 1
    v_lshl_add_u32 v4, v6, 2, v4
    v_cmp_eq_u32 vcc, 0, v4
    s_nop 1
    v_cndmask_b32 v208, 0, v3, vcc
    v_cmp_eq_u32 vcc, 1, v4
    buffer_load_dwordx4 v17, s[56:59], s83 offen offset:1024 lds
    s_nop 0
    v_cndmask_b32 v209, 0, v3, vcc
    v_cmp_eq_u32 vcc, 2, v4
    s_nop 1
    v_cndmask_b32 v210, 0, v3, vcc
    v_cmp_eq_u32 vcc, 3, v4
    s_nop 1
    v_cndmask_b32 v211, 0, v3, vcc
    v_cmp_eq_u32 vcc, 4, v4
    s_nop 1
    v_cndmask_b32 v212, 0, v3, vcc
    v_cmp_eq_u32 vcc, 5, v4
    s_nop 1
    v_cndmask_b32 v213, 0, v3, vcc
    v_cmp_eq_u32 vcc, 6, v4
    s_nop 1
    v_cndmask_b32 v214, 0, v3, vcc
    v_cmp_eq_u32 vcc, 7, v4
    buffer_load_dwordx4 v18, s[56:59], s83 offen offset:2048 lds
    s_nop 0
    v_cndmask_b32 v215, 0, v3, vcc
    v_mfma_f32_32x32x16_bf16 v[64:79], v[244:247], v[208:211], 0
    s_nop 0
    v_mfma_f32_32x32x16_bf16 v[64:79], v[248:251], v[212:215], v[64:79]
    v_bfe_u32 v5, v0, 1, 1
    v_xor_b32 v4, v6, v43
    v_lshl_add_u32 v4, v6, 1, v4
    buffer_load_dwordx4 v19, s[56:59], s83 offen offset:3072 lds
    s_add_u32 s83, s83, 384
    s_cmp_ge_u32 s83, 1280
    s_cselect_b32 s66, 1280, 0
    s_sub_u32 s83, s83, s66
    v_lshlrev_b32 v4, 1, v4
    v_xor_b32 v4, v4, v5
    v_bfe_u32 v6, v0, 2, 2
    v_lshl_add_u32 v6, v4, 2, v6
    v_lshlrev_b32 v6, 4, v6
    v_lshl_add_u32 v6, v5, 10, v6
    v_lshl_add_u32 v6, v7, 3, v6
    s_mul_i32 s13, s65, 2560
    v_add_u32 v8, s13, v6
    v_xor_b32 v9, 64, v8
    v_add_u32 v10, 0x10000, v8
    v_add_u32 v11, 0x10000, v9
    s_add_u32 m0, s82, 32768
    s_nop 0
    buffer_load_dwordx4 v16, s[56:59], s83 offen offset:0 lds
    v_xor_b32 v12, 0x200, v8
    v_xor_b32 v13, 0x200, v9
    v_xor_b32 v14, 0x200, v10
    v_xor_b32 v15, 0x200, v11
    v_mov_b32 v30, v39
    s_lshl_b32 s16, s3, 11
    buffer_load_dwordx4 v17, s[56:59], s83 offen offset:1024 lds
    v_cmp_gt_u32 vcc, 10, v0
    s_nop 1
    v_cndmask_b32 v3, 0, v0, vcc
    v_lshlrev_b32 v3, 2, v3
    s_add_u32 s13, s82, 0x18000
    v_add_u32 v5, s13, v1
    v_xor_b32 v6, 0x4000, v5
    v_mul_u32_u24 v7, 20480, v43
    v_lshl_add_u32 v7, v42, 2, v7
    s_lshl_b32 s17, s10, 1
    s_add_u32 s17, s17, s65
    s_mul_i32 s17, s17, 163840
    s_lshl_b32 s14, s7, 9
    buffer_load_dwordx4 v18, s[56:59], s83 offen offset:2048 lds
    s_add_u32 s17, s17, s14
    s_lshl_b32 s14, s64, 7
    s_add_u32 s17, s17, s14
    s_add_u32 s17, s17, 2560
    s_mul_i32 s23, s10, 163840
    s_add_u32 s23, s23, s16
    buffer_load_dwordx4 v19, s[56:59], s83 offen offset:3072 lds
    s_add_u32 s83, s83, 384
    s_cmp_ge_u32 s83, 1280
    s_cselect_b32 s66, 1280, 0
    s_sub_u32 s83, s83, s66
    s_add_u32 s23, s23, 0x400000
    s_mov_b32 s72, s46
    s_mov_b32 s73, s47
    s_mov_b32 s74, 0xa00000
    s_mov_b32 s75, 0x20000
    s_add_u32 s14, s23, 163840
    s_lshl_b32 s30, s11, 14
    s_add_u32 s30, s30, s23
    s_add_u32 s31, s30, 49152
    s_cmp_ge_u32 s31, s14
    s_cselect_b32 s13, 163840, 0
    s_sub_u32 s31, s31, s13
    s_add_u32 s32, s31, 49152
    s_cmp_ge_u32 s32, s14
    s_cselect_b32 s13, 163840, 0
    s_sub_u32 s32, s32, s13
    s_add_u32 s33, s32, 49152
    s_cmp_ge_u32 s33, s14
    s_cselect_b32 s13, 163840, 0
    s_sub_u32 s33, s33, s13
    s_add_u32 s34, s33, 49152
    s_cmp_ge_u32 s34, s14
    s_cselect_b32 s13, 163840, 0
    s_sub_u32 s34, s34, s13
    s_add_u32 s35, s34, 49152
    s_cmp_ge_u32 s35, s14
    s_cselect_b32 s13, 163840, 0
    s_sub_u32 s35, s35, s13
    s_add_u32 s36, s35, 49152
    s_cmp_ge_u32 s36, s14
    s_cselect_b32 s13, 163840, 0
    s_sub_u32 s36, s36, s13
    s_add_u32 s37, s36, 49152
    s_cmp_ge_u32 s37, s14
    s_cselect_b32 s13, 163840, 0
    s_sub_u32 s37, s37, s13
    s_add_u32 s38, s37, 49152
    s_cmp_ge_u32 s38, s14
    s_cselect_b32 s13, 163840, 0
    s_sub_u32 s38, s38, s13
    s_add_u32 s39, s38, 49152
    s_cmp_ge_u32 s39, s14
    s_cselect_b32 s13, 163840, 0
    s_sub_u32 s39, s39, s13
    s_waitcnt vmcnt(8)
    s_barrier
    s_cmp_lg_u32 s3, 0
    s_cbranch_scc1 Lhflag_9
    s_mov_b64 exec, 1
    buffer_store_dword v39, v40, s[68:71], s21 offen sc1
    s_mov_b64 exec, -1
Lhflag_9:
    s_lshr_b32 s13, s64, 1
    s_and_b32 s14, s10, 1
    s_cmp_lg_u32 s13, s14
    s_cbranch_scc1 Lown_10
    ds_write_b128 v28, v[224:227] offset:0
    ds_write_b128 v28, v[232:235] offset:2048
    ds_write_b128 v29, v[228:231] offset:1024
    ds_write_b128 v29, v[236:239] offset:3072
Lown_10:
    s_add_u32 m0, s82, 98304
    s_nop 0
    buffer_load_dwordx4 v16, s[56:59], s83 offen offset:0 lds
    buffer_load_dwordx4 v17, s[56:59], s83 offen offset:1024 lds
    buffer_load_dwordx4 v18, s[56:59], s83 offen offset:2048 lds
    buffer_load_dwordx4 v19, s[56:59], s83 offen offset:3072 lds
    s_add_u32 s83, s83, 384
    s_cmp_ge_u32 s83, 1280
    s_cselect_b32 s66, 1280, 0
    s_sub_u32 s83, s83, s66
    s_add_u32 m0, s82, 131072
    s_nop 0
    buffer_load_dwordx4 v16, s[56:59], s83 offen offset:0 lds
    buffer_load_dwordx4 v17, s[56:59], s83 offen offset:1024 lds
    buffer_load_dwordx4 v18, s[56:59], s83 offen offset:2048 lds
    buffer_load_dwordx4 v19, s[56:59], s83 offen offset:3072 lds
    s_add_u32 s83, s83, 384
    s_cmp_ge_u32 s83, 1280
    s_cselect_b32 s66, 1280, 0
    s_sub_u32 s83, s83, s66
    s_waitcnt lgkmcnt(0)
    s_barrier
    ds_read_b64_tr_b16 v[32:33], v10 offset:0
    ds_read_b64_tr_b16 v[34:35], v11 offset:0
    ds_read_b64_tr_b16 v[36:37], v14 offset:0
    ds_read_b64_tr_b16 v[38:39], v15 offset:0
    ds_read_b64_tr_b16 v[40:41], v10 offset:4096
    ds_read_b64_tr_b16 v[42:43], v11 offset:4096
    ds_read_b64_tr_b16 v[44:45], v14 offset:4096
    ds_read_b64_tr_b16 v[46:47], v15 offset:4096
    ds_read_b64_tr_b16 v[48:49], v10 offset:8192
    ds_read_b64_tr_b16 v[50:51], v11 offset:8192
    ds_read_b64_tr_b16 v[52:53], v14 offset:8192
    ds_read_b64_tr_b16 v[54:55], v15 offset:8192
    ds_read_b64_tr_b16 v[56:57], v10 offset:12288
    ds_read_b64_tr_b16 v[58:59], v11 offset:12288
    ds_read_b64_tr_b16 v[60:61], v14 offset:12288
    ds_read_b64_tr_b16 v[62:63], v15 offset:12288
    s_waitcnt vmcnt(8)
    ds_read_b128 v[160:163], v20 offset:0
    ds_read_b128 v[164:167], v21 offset:0
    ds_read_b128 v[168:171], v22 offset:0
    ds_read_b128 v[172:175], v23 offset:0
    ds_read_b128 v[176:179], v20 offset:32768
    ds_read_b128 v[180:183], v21 offset:32768
    ds_read_b128 v[184:187], v22 offset:32768
    ds_read_b128 v[188:191], v23 offset:32768
    s_waitcnt lgkmcnt(8)
    v_mfma_f32_32x32x16_bf16 v[64:79], v[32:35], v[96:99], v[64:79]
    v_mfma_f32_32x32x16_bf16 v[80:95], v[36:39], v[96:99], 0
    v_mfma_f32_32x32x16_bf16 v[64:79], v[40:43], v[100:103], v[64:79]
    v_mfma_f32_32x32x16_bf16 v[80:95], v[44:47], v[100:103], v[80:95]
    v_mfma_f32_32x32x16_bf16 v[64:79], v[48:51], v[104:107], v[64:79]
    v_mfma_f32_32x32x16_bf16 v[80:95], v[52:55], v[104:107], v[80:95]
    v_mfma_f32_32x32x16_bf16 v[64:79], v[56:59], v[108:111], v[64:79]
    v_mfma_f32_32x32x16_bf16 v[80:95], v[60:63], v[108:111], v[80:95]
    s_cmp_lg_u32 s3, 0
    s_cbranch_scc1 Lhdone_12
    s_mov_b32 s15, 20000
Lhpoll_11:
    buffer_load_dword v4, v3, s[68:71], s22 offen sc1
    s_waitcnt vmcnt(0)
    v_cmp_ne_u32 vcc, v4, v30
    s_cbranch_vccz Lhdone_12
    s_sub_u32 s15, s15, 1
    s_cmp_lg_u32 s15, 0
    s_cbranch_scc1 Lhpoll_11
Lhdone_12:
    s_waitcnt lgkmcnt(0)
    v_add_u32 v20, 0x18000, v20
    v_add_u32 v21, 0x18000, v21
    v_add_u32 v22, 0x18000, v22
    v_add_u32 v23, 0x18000, v23
    s_barrier
    s_add_u32 m0, s16, 81920
    s_nop 0
    buffer_load_dwordx4 v1, s[68:71], s31 offen offset:0 sc1 lds
    buffer_load_dwordx4 v1, s[68:71], s31 offen offset:1024 sc1 lds
    s_add_u32 m0, s16, 0
    s_nop 0
    buffer_load_dwordx4 v1, s[68:71], s32 offen offset:0 sc1 lds
    buffer_load_dwordx4 v1, s[68:71], s32 offen offset:1024 sc1 lds
    s_waitcnt vmcnt(4)
    ds_read_b128 v[192:195], v20 offset:0
    ds_read_b128 v[196:199], v21 offset:0
    ds_read_b128 v[200:203], v22 offset:0
    ds_read_b128 v[204:207], v23 offset:0
    ds_read_b128 v[208:211], v20 offset:32768
    ds_read_b128 v[212:215], v21 offset:32768
    ds_read_b128 v[216:219], v22 offset:32768
    ds_read_b128 v[220:223], v23 offset:32768
    s_waitcnt vmcnt(2) lgkmcnt(0)
    s_barrier
    ds_read_b64_tr_b16 v[32:33], v10 offset:16384
    ds_read_b64_tr_b16 v[34:35], v11 offset:16384
    ds_read_b64_tr_b16 v[36:37], v14 offset:16384
    ds_read_b64_tr_b16 v[38:39], v15 offset:16384
    ds_read_b64_tr_b16 v[40:41], v10 offset:20480
    ds_read_b64_tr_b16 v[42:43], v11 offset:20480
    ds_read_b64_tr_b16 v[44:45], v14 offset:20480
    ds_read_b64_tr_b16 v[46:47], v15 offset:20480
    s_add_u32 m0, s16, 16384
    s_nop 0
    buffer_load_dwordx4 v1, s[68:71], s33 offen offset:0 sc1 lds
    buffer_load_dwordx4 v1, s[68:71], s33 offen offset:1024 sc1 lds
    s_waitcnt lgkmcnt(0)
    v_mfma_f32_32x32x16_bf16 v[64:79], v[32:35], v[112:115], v[64:79]
    ds_read_b64_tr_b16 v[48:49], v10 offset:24576
    ds_read_b64_tr_b16 v[50:51], v11 offset:24576
    ds_read_b64_tr_b16 v[52:53], v14 offset:24576
    v_mfma_f32_32x32x16_bf16 v[80:95], v[36:39], v[112:115], v[80:95]
    ds_read_b64_tr_b16 v[54:55], v15 offset:24576
    ds_read_b64_tr_b16 v[56:57], v10 offset:28672
    ds_read_b64_tr_b16 v[58:59], v11 offset:28672
    v_mfma_f32_32x32x16_bf16 v[64:79], v[40:43], v[116:119], v[64:79]
    ds_read_b64_tr_b16 v[60:61], v14 offset:28672
    ds_read_b64_tr_b16 v[62:63], v15 offset:28672
    s_waitcnt vmcnt(2)
    s_barrier
    s_add_u32 m0, s16, 32768
    s_nop 0
    buffer_load_dwordx4 v1, s[68:71], s34 offen offset:0 sc1 lds
    buffer_load_dwordx4 v1, s[68:71], s34 offen offset:1024 sc1 lds
    v_mfma_f32_32x32x16_bf16 v[80:95], v[44:47], v[116:119], v[80:95]
    s_waitcnt lgkmcnt(0)
    v_mfma_f32_32x32x16_bf16 v[64:79], v[48:51], v[120:123], v[64:79]
    ds_read_b64_tr_b16 v[32:33], v8 offset:0
    ds_read_b64_tr_b16 v[34:35], v9 offset:0
    ds_read_b64_tr_b16 v[36:37], v12 offset:0
    v_mfma_f32_32x32x16_bf16 v[80:95], v[52:55], v[120:123], v[80:95]
    ds_read_b64_tr_b16 v[38:39], v13 offset:0
    ds_read_b64_tr_b16 v[40:41], v8 offset:4096
    ds_read_b64_tr_b16 v[42:43], v9 offset:4096
    v_mfma_f32_32x32x16_bf16 v[64:79], v[56:59], v[124:127], v[64:79]
    ds_read_b64_tr_b16 v[44:45], v12 offset:4096
    ds_read_b64_tr_b16 v[46:47], v13 offset:4096
    s_add_u32 m0, s16, 49152
    s_nop 0
    buffer_load_dwordx4 v1, s[68:71], s35 offen offset:0 sc1 lds
    buffer_load_dwordx4 v1, s[68:71], s35 offen offset:1024 sc1 lds
    v_mfma_f32_32x32x16_bf16 v[80:95], v[60:63], v[124:127], v[80:95]
    s_waitcnt lgkmcnt(0)
    v_mfma_f32_32x32x16_bf16 v[64:79], v[32:35], v[128:131], v[64:79]
    ds_read_b64_tr_b16 v[48:49], v8 offset:8192
    ds_read_b64_tr_b16 v[50:51], v9 offset:8192
    ds_read_b64_tr_b16 v[52:53], v12 offset:8192
    v_mfma_f32_32x32x16_bf16 v[80:95], v[36:39], v[128:131], v[80:95]
    ds_read_b64_tr_b16 v[54:55], v13 offset:8192
    ds_read_b64_tr_b16 v[56:57], v8 offset:12288
    ds_read_b64_tr_b16 v[58:59], v9 offset:12288
    v_mfma_f32_32x32x16_bf16 v[64:79], v[40:43], v[132:135], v[64:79]
    ds_read_b64_tr_b16 v[60:61], v12 offset:12288
    ds_read_b64_tr_b16 v[62:63], v13 offset:12288
    s_waitcnt vmcnt(4)
    s_barrier
    s_add_u32 m0, s16, 65536
    s_nop 0
    buffer_load_dwordx4 v1, s[68:71], s36 offen offset:0 sc1 lds
    buffer_load_dwordx4 v1, s[68:71], s36 offen offset:1024 sc1 lds
    v_mfma_f32_32x32x16_bf16 v[80:95], v[44:47], v[132:135], v[80:95]
    s_waitcnt lgkmcnt(0)
    v_mfma_f32_32x32x16_bf16 v[64:79], v[48:51], v[136:139], v[64:79]
    ds_read_b64_tr_b16 v[32:33], v8 offset:16384
    ds_read_b64_tr_b16 v[34:35], v9 offset:16384
    ds_read_b64_tr_b16 v[36:37], v12 offset:16384
    v_mfma_f32_32x32x16_bf16 v[80:95], v[52:55], v[136:139], v[80:95]
    ds_read_b64_tr_b16 v[38:39], v13 offset:16384
    ds_read_b64_tr_b16 v[40:41], v8 offset:20480
    ds_read_b64_tr_b16 v[42:43], v9 offset:20480
    v_mfma_f32_32x32x16_bf16 v[64:79], v[56:59], v[140:143], v[64:79]
    ds_read_b64_tr_b16 v[44:45], v12 offset:20480
    ds_read_b64_tr_b16 v[46:47], v13 offset:20480
    s_add_u32 m0, s16, 81920
    s_nop 0
    buffer_load_dwordx4 v1, s[68:71], s37 offen offset:0 sc1 lds
    buffer_load_dwordx4 v1, s[68:71], s37 offen offset:1024 sc1 lds
    v_mfma_f32_32x32x16_bf16 v[80:95], v[60:63], v[140:143], v[80:95]
    s_waitcnt lgkmcnt(0)
    v_mfma_f32_32x32x16_bf16 v[64:79], v[32:35], v[144:147], v[64:79]
    ds_read_b64_tr_b16 v[48:49], v8 offset:24576
    ds_read_b64_tr_b16 v[50:51], v9 offset:24576
    ds_read_b64_tr_b16 v[52:53], v12 offset:24576
    v_mfma_f32_32x32x16_bf16 v[80:95], v[36:39], v[144:147], v[80:95]
    ds_read_b64_tr_b16 v[54:55], v13 offset:24576
    ds_read_b64_tr_b16 v[56:57], v8 offset:28672
    ds_read_b64_tr_b16 v[58:59], v9 offset:28672
    v_mfma_f32_32x32x16_bf16 v[64:79], v[40:43], v[148:151], v[64:79]
    ds_read_b64_tr_b16 v[60:61], v12 offset:28672
    ds_read_b64_tr_b16 v[62:63], v13 offset:28672
    s_waitcnt vmcnt(6)
    s_barrier
    s_add_u32 m0, s82, 98304
    s_nop 0
    buffer_load_dwordx4 v16, s[56:59], s83 offen offset:0 lds
    v_mfma_f32_32x32x16_bf16 v[80:95], v[44:47], v[148:151], v[80:95]
    s_add_u32 m0, s82, 98304
    s_nop 0
    buffer_load_dwordx4 v17, s[56:59], s83 offen offset:1024 lds
    s_waitcnt lgkmcnt(0)
    v_mfma_f32_32x32x16_bf16 v[64:79], v[48:51], v[152:155], v[64:79]
    ds_read_b64_tr_b16 v[32:33], v8 offset:32768
    ds_read_b64_tr_b16 v[34:35], v9 offset:32768
    ds_read_b64_tr_b16 v[36:37], v12 offset:32768
    v_mfma_f32_32x32x16_bf16 v[80:95], v[52:55], v[152:155], v[80:95]
    ds_read_b64_tr_b16 v[38:39], v13 offset:32768
    ds_read_b64_tr_b16 v[40:41], v8 offset:36864
    ds_read_b64_tr_b16 v[42:43], v9 offset:36864
    v_mfma_f32_32x32x16_bf16 v[64:79], v[56:59], v[156:159], v[64:79]
    ds_read_b64_tr_b16 v[44:45], v12 offset:36864
    ds_read_b64_tr_b16 v[46:47], v13 offset:36864
    s_add_u32 m0, s16, 0
    s_nop 0
    buffer_load_dwordx4 v1, s[68:71], s38 offen offset:0 sc1 lds
    buffer_load_dwordx4 v1, s[68:71], s38 offen offset:1024 sc1 lds
    v_mfma_f32_32x32x16_bf16 v[80:95], v[60:63], v[156:159], v[80:95]
    s_waitcnt lgkmcnt(0)
    v_mfma_f32_32x32x16_bf16 v[64:79], v[32:35], v[160:163], v[64:79]
    ds_read_b64_tr_b16 v[48:49], v8 offset:40960
    ds_read_b64_tr_b16 v[50:51], v9 offset:40960
    ds_read_b64_tr_b16 v[52:53], v12 offset:40960
    v_mfma_f32_32x32x16_bf16 v[80:95], v[36:39], v[160:163], v[80:95]
    ds_read_b64_tr_b16 v[54:55], v13 offset:40960
    ds_read_b64_tr_b16 v[56:57], v8 offset:45056
    ds_read_b64_tr_b16 v[58:59], v9 offset:45056
    v_mfma_f32_32x32x16_bf16 v[64:79], v[40:43], v[164:167], v[64:79]
    ds_read_b64_tr_b16 v[60:61], v12 offset:45056
    ds_read_b64_tr_b16 v[62:63], v13 offset:45056
    s_waitcnt vmcnt(8)
    s_barrier
    s_add_u32 m0, s82, 98304
    s_nop 0
    buffer_load_dwordx4 v18, s[56:59], s83 offen offset:2048 lds
    v_mfma_f32_32x32x16_bf16 v[80:95], v[44:47], v[164:167], v[80:95]
    s_add_u32 m0, s82, 98304
    s_nop 0
    buffer_load_dwordx4 v19, s[56:59], s83 offen offset:3072 lds
    s_add_u32 s83, s83, 384
    s_cmp_ge_u32 s83, 1280
    s_cselect_b32 s66, 1280, 0
    s_sub_u32 s83, s83, s66
    s_waitcnt lgkmcnt(0)
    v_mfma_f32_32x32x16_bf16 v[64:79], v[48:51], v[168:171], v[64:79]
    ds_read_b64_tr_b16 v[32:33], v8 offset:49152
    ds_read_b64_tr_b16 v[34:35], v9 offset:49152
    ds_read_b64_tr_b16 v[36:37], v12 offset:49152
    v_mfma_f32_32x32x16_bf16 v[80:95], v[52:55], v[168:171], v[80:95]
    ds_read_b64_tr_b16 v[38:39], v13 offset:49152
    ds_read_b64_tr_b16 v[40:41], v8 offset:53248
    ds_read_b64_tr_b16 v[42:43], v9 offset:53248
    v_mfma_f32_32x32x16_bf16 v[64:79], v[56:59], v[172:175], v[64:79]
    ds_read_b64_tr_b16 v[44:45], v12 offset:53248
    ds_read_b64_tr_b16 v[46:47], v13 offset:53248
    s_add_u32 m0, s16, 16384
    s_nop 0
    buffer_load_dwordx4 v1, s[68:71], s39 offen offset:0 sc1 lds
    buffer_load_dwordx4 v1, s[68:71], s39 offen offset:1024 sc1 lds
    v_mfma_f32_32x32x16_bf16 v[80:95], v[60:63], v[172:175], v[80:95]
    s_waitcnt lgkmcnt(0)
    s_waitcnt vmcnt(2)
    v_mfma_f32_32x32x16_bf16 v[64:79], v[32:35], v[176:179], v[64:79]
    ds_read_b64_tr_b16 v[48:49], v8 offset:57344
    ds_read_b64_tr_b16 v[50:51], v9 offset:57344
    ds_read_b64_tr_b16 v[52:53], v12 offset:57344
    v_mfma_f32_32x32x16_bf16 v[80:95], v[36:39], v[176:179], v[80:95]
    ds_read_b64_tr_b16 v[54:55], v13 offset:57344
    ds_read_b64_tr_b16 v[56:57], v8 offset:61440
    ds_read_b64_tr_b16 v[58:59], v9 offset:61440
    v_mfma_f32_32x32x16_bf16 v[64:79], v[40:43], v[180:183], v[64:79]
    ds_read_b64_tr_b16 v[60:61], v12 offset:61440
    ds_read_b64_tr_b16 v[62:63], v13 offset:61440
    ds_read_b128 v[224:227], v20 offset:0
    s_barrier
    s_add_u32 m0, s82, 131072
    s_nop 0
    buffer_load_dwordx4 v16, s[56:59], s83 offen offset:0 lds
    v_mfma_f32_32x32x16_bf16 v[80:95], v[44:47], v[180:183], v[80:95]
    ds_read_b128 v[228:231], v21 offset:0
    ds_read_b128 v[232:235], v22 offset:0
    ds_read_b128 v[236:239], v23 offset:0
    s_add_u32 m0, s82, 131072
    s_nop 0
    buffer_load_dwordx4 v17, s[56:59], s83 offen offset:1024 lds
    s_waitcnt lgkmcnt(0)
    v_mfma_f32_32x32x16_bf16 v[64:79], v[48:51], v[184:187], v[64:79]
    ds_read_b64_tr_b16 v[32:33], v10 offset:0
    ds_read_b64_tr_b16 v[34:35], v11 offset:0
    ds_read_b64_tr_b16 v[36:37], v14 offset:0
    v_mfma_f32_32x32x16_bf16 v[80:95], v[52:55], v[184:187], v[80:95]
    ds_read_b64_tr_b16 v[38:39], v15 offset:0
    ds_read_b64_tr_b16 v[40:41], v10 offset:4096
    ds_read_b64_tr_b16 v[42:43], v11 offset:4096
    v_mfma_f32_32x32x16_bf16 v[64:79], v[56:59], v[188:191], v[64:79]
    ds_read_b64_tr_b16 v[44:45], v14 offset:4096
    ds_read_b64_tr_b16 v[46:47], v15 offset:4096
    s_add_u32 m0, s82, 131072
    s_nop 0
    buffer_load_dwordx4 v18, s[56:59], s83 offen offset:2048 lds
    v_mfma_f32_32x32x16_bf16 v[80:95], v[60:63], v[188:191], v[80:95]
    s_add_u32 m0, s82, 131072
    s_nop 0
    buffer_load_dwordx4 v19, s[56:59], s83 offen offset:3072 lds
    s_add_u32 s83, s83, 384
    s_cmp_ge_u32 s83, 1280
    s_cselect_b32 s66, 1280, 0
    s_sub_u32 s83, s83, s66
    s_waitcnt lgkmcnt(0)
    v_mfma_f32_32x32x16_bf16 v[64:79], v[32:35], v[192:195], v[64:79]
    ds_read_b64_tr_b16 v[48:49], v10 offset:8192
    ds_read_b64_tr_b16 v[50:51], v11 offset:8192
    ds_read_b64_tr_b16 v[52:53], v14 offset:8192
    v_mfma_f32_32x32x16_bf16 v[80:95], v[36:39], v[192:195], v[80:95]
    ds_read_b64_tr_b16 v[54:55], v15 offset:8192
    ds_read_b64_tr_b16 v[56:57], v10 offset:12288
    ds_read_b64_tr_b16 v[58:59], v11 offset:12288
    v_mfma_f32_32x32x16_bf16 v[64:79], v[40:43], v[196:199], v[64:79]
    ds_read_b64_tr_b16 v[60:61], v14 offset:12288
    ds_read_b64_tr_b16 v[62:63], v15 offset:12288
    v_mfma_f32_32x32x16_bf16 v[80:95], v[44:47], v[196:199], v[80:95]
    s_waitcnt lgkmcnt(0)
    s_waitcnt vmcnt(0)
    v_mfma_f32_32x32x16_bf16 v[64:79], v[48:51], v[200:203], v[64:79]
    ds_read_b64_tr_b16 v[32:33], v10 offset:16384
    ds_read_b64_tr_b16 v[34:35], v11 offset:16384
    ds_read_b64_tr_b16 v[36:37], v14 offset:16384
    v_mfma_f32_32x32x16_bf16 v[80:95], v[52:55], v[200:203], v[80:95]
    ds_read_b64_tr_b16 v[38:39], v15 offset:16384
    ds_read_b64_tr_b16 v[40:41], v10 offset:20480
    ds_read_b64_tr_b16 v[42:43], v11 offset:20480
    v_mfma_f32_32x32x16_bf16 v[64:79], v[56:59], v[204:207], v[64:79]
    ds_read_b64_tr_b16 v[44:45], v14 offset:20480
    ds_read_b64_tr_b16 v[46:47], v15 offset:20480
    ds_read_b128 v[240:243], v20 offset:32768
    v_mfma_f32_32x32x16_bf16 v[80:95], v[60:63], v[204:207], v[80:95]
    ds_read_b128 v[244:247], v21 offset:32768
    ds_read_b128 v[248:251], v22 offset:32768
    ds_read_b128 v[252:255], v23 offset:32768
    s_waitcnt lgkmcnt(0)
    v_mfma_f32_32x32x16_bf16 v[64:79], v[32:35], v[208:211], v[64:79]
    ds_read_b64_tr_b16 v[48:49], v10 offset:24576
    ds_read_b64_tr_b16 v[50:51], v11 offset:24576
    ds_read_b64_tr_b16 v[52:53], v14 offset:24576
    v_mfma_f32_32x32x16_bf16 v[80:95], v[36:39], v[208:211], v[80:95]
    ds_read_b64_tr_b16 v[54:55], v15 offset:24576
    ds_read_b64_tr_b16 v[56:57], v10 offset:28672
    ds_read_b64_tr_b16 v[58:59], v11 offset:28672
    v_mfma_f32_32x32x16_bf16 v[64:79], v[40:43], v[212:215], v[64:79]
    ds_read_b64_tr_b16 v[60:61], v14 offset:28672
    ds_read_b64_tr_b16 v[62:63], v15 offset:28672
    s_barrier
    v_mfma_f32_32x32x16_bf16 v[80:95], v[44:47], v[212:215], v[80:95]
    s_waitcnt lgkmcnt(0)
    v_mfma_f32_32x32x16_bf16 v[64:79], v[48:51], v[216:219], v[64:79]
    ds_read_b64_tr_b16 v[32:33], v8 offset:0
    ds_read_b64_tr_b16 v[34:35], v9 offset:0
    ds_read_b64_tr_b16 v[36:37], v12 offset:0
    v_mfma_f32_32x32x16_bf16 v[80:95], v[52:55], v[216:219], v[80:95]
    ds_read_b64_tr_b16 v[38:39], v13 offset:0
    ds_read_b64_tr_b16 v[40:41], v8 offset:4096
    ds_read_b64_tr_b16 v[42:43], v9 offset:4096
    v_mfma_f32_32x32x16_bf16 v[64:79], v[56:59], v[220:223], v[64:79]
    ds_read_b64_tr_b16 v[44:45], v12 offset:4096
    ds_read_b64_tr_b16 v[46:47], v13 offset:4096
    v_mfma_f32_32x32x16_bf16 v[80:95], v[60:63], v[220:223], v[80:95]
    s_waitcnt lgkmcnt(0)
    v_mfma_f32_32x32x16_bf16 v[64:79], v[32:35], v[224:227], v[64:79]
    ds_read_b64_tr_b16 v[48:49], v8 offset:8192
    ds_read_b64_tr_b16 v[50:51], v9 offset:8192
    ds_read_b64_tr_b16 v[52:53], v12 offset:8192
    v_mfma_f32_32x32x16_bf16 v[80:95], v[36:39], v[224:227], v[80:95]
    ds_read_b64_tr_b16 v[54:55], v13 offset:8192
    ds_read_b64_tr_b16 v[56:57], v8 offset:12288
    ds_read_b64_tr_b16 v[58:59], v9 offset:12288
    v_mfma_f32_32x32x16_bf16 v[64:79], v[40:43], v[228:231], v[64:79]
    ds_read_b64_tr_b16 v[60:61], v12 offset:12288
    ds_read_b64_tr_b16 v[62:63], v13 offset:12288
    v_mfma_f32_32x32x16_bf16 v[80:95], v[44:47], v[228:231], v[80:95]
    s_waitcnt lgkmcnt(0)
    v_mfma_f32_32x32x16_bf16 v[64:79], v[48:51], v[232:235], v[64:79]
    ds_read_b64_tr_b16 v[32:33], v8 offset:16384
    ds_read_b64_tr_b16 v[34:35], v9 offset:16384
    ds_read_b64_tr_b16 v[36:37], v12 offset:16384
    v_mfma_f32_32x32x16_bf16 v[80:95], v[52:55], v[232:235], v[80:95]
    ds_read_b64_tr_b16 v[38:39], v13 offset:16384
    ds_read_b64_tr_b16 v[40:41], v8 offset:20480
    ds_read_b64_tr_b16 v[42:43], v9 offset:20480
    v_mfma_f32_32x32x16_bf16 v[64:79], v[56:59], v[236:239], v[64:79]
    ds_read_b64_tr_b16 v[44:45], v12 offset:20480
    ds_read_b64_tr_b16 v[46:47], v13 offset:20480
    v_mfma_f32_32x32x16_bf16 v[80:95], v[60:63], v[236:239], v[80:95]
    s_waitcnt lgkmcnt(0)
    v_mfma_f32_32x32x16_bf16 v[64:79], v[32:35], v[240:243], v[64:79]
    ds_read_b64_tr_b16 v[48:49], v8 offset:24576
    ds_read_b64_tr_b16 v[50:51], v9 offset:24576
    ds_read_b64_tr_b16 v[52:53], v12 offset:24576
    v_mfma_f32_32x32x16_bf16 v[80:95], v[36:39], v[240:243], v[80:95]
    ds_read_b64_tr_b16 v[54:55], v13 offset:24576
    ds_read_b64_tr_b16 v[56:57], v8 offset:28672
    ds_read_b64_tr_b16 v[58:59], v9 offset:28672
    v_mfma_f32_32x32x16_bf16 v[64:79], v[40:43], v[244:247], v[64:79]
    ds_read_b64_tr_b16 v[60:61], v12 offset:28672
    ds_read_b64_tr_b16 v[62:63], v13 offset:28672
    v_mfma_f32_32x32x16_bf16 v[80:95], v[44:47], v[244:247], v[80:95]
    s_waitcnt lgkmcnt(0)
    v_mfma_f32_32x32x16_bf16 v[80:95], v[52:55], v[248:251], v[80:95]
    v_mfma_f32_32x32x16_bf16 v[80:95], v[60:63], v[252:255], v[80:95]
    v_mfma_f32_32x32x16_bf16 v[64:79], v[48:51], v[248:251], v[64:79]
    v_mfma_f32_32x32x16_bf16 v[64:79], v[56:59], v[252:255], v[64:79]
    s_nop 9
    ds_write_b128 v5, v[80:83] offset:0
    ds_write_b128 v5, v[84:87] offset:1024
    ds_write_b128 v5, v[88:91] offset:2048
    ds_write_b128 v5, v[92:95] offset:3072
    s_waitcnt lgkmcnt(0)
    s_barrier
    ds_read_b128 v[128:131], v6 offset:0
    ds_read_b128 v[132:135], v6 offset:1024
    ds_read_b128 v[136:139], v6 offset:2048
    ds_read_b128 v[140:143], v6 offset:3072
    s_waitcnt lgkmcnt(3)
    v_add_f32 v128, v128, v64
    buffer_store_dword v128, v7, s[72:75], s17 offen sc1 nt
    s_add_u32 s17, s17, 5120
    v_add_f32 v129, v129, v65
    buffer_store_dword v129, v7, s[72:75], s17 offen sc1 nt
    s_add_u32 s17, s17, 5120
    v_add_f32 v130, v130, v66
    buffer_store_dword v130, v7, s[72:75], s17 offen sc1 nt
    s_add_u32 s17, s17, 5120
    v_add_f32 v131, v131, v67
    buffer_store_dword v131, v7, s[72:75], s17 offen sc1 nt
    s_add_u32 s17, s17, 25600
    s_waitcnt lgkmcnt(2)
    v_add_f32 v132, v132, v68
    buffer_store_dword v132, v7, s[72:75], s17 offen sc1 nt
    s_add_u32 s17, s17, 5120
    v_add_f32 v133, v133, v69
    buffer_store_dword v133, v7, s[72:75], s17 offen sc1 nt
    s_add_u32 s17, s17, 5120
    v_add_f32 v134, v134, v70
    buffer_store_dword v134, v7, s[72:75], s17 offen sc1 nt
    s_add_u32 s17, s17, 5120
    v_add_f32 v135, v135, v71
    buffer_store_dword v135, v7, s[72:75], s17 offen sc1 nt
    s_add_u32 s17, s17, 25600
    s_waitcnt lgkmcnt(1)
    v_add_f32 v136, v136, v72
    buffer_store_dword v136, v7, s[72:75], s17 offen sc1 nt
    s_add_u32 s17, s17, 5120
    v_add_f32 v137, v137, v73
    buffer_store_dword v137, v7, s[72:75], s17 offen sc1 nt
    s_add_u32 s17, s17, 5120
    v_add_f32 v138, v138, v74
    buffer_store_dword v138, v7, s[72:75], s17 offen sc1 nt
    s_add_u32 s17, s17, 5120
    v_add_f32 v139, v139, v75
    buffer_store_dword v139, v7, s[72:75], s17 offen sc1 nt
    s_add_u32 s17, s17, 25600
    s_waitcnt lgkmcnt(0)
    v_add_f32 v140, v140, v76
    buffer_store_dword v140, v7, s[72:75], s17 offen sc1 nt
    s_add_u32 s17, s17, 5120
    v_add_f32 v141, v141, v77
    buffer_store_dword v141, v7, s[72:75], s17 offen sc1 nt
    s_add_u32 s17, s17, 5120
    v_add_f32 v142, v142, v78
    buffer_store_dword v142, v7, s[72:75], s17 offen sc1 nt
    s_add_u32 s17, s17, 5120
    v_add_f32 v143, v143, v79
    buffer_store_dword v143, v7, s[72:75], s17 offen sc1 nt
    s_endpgm
L_roleA:
    s_mul_i32 s6, s4, 10
    s_add_u32 s6, s6, s5
    s_sub_u32 s6, s6, 20
    s_and_b32 s7, s6, 7
    s_lshr_b32 s8, s6, 3
    s_lshl_b32 s9, s6, 3
    s_add_u32 s9, s9, s3
    s_mul_i32 s10, s3, 20480
    s_add_u32 s11, s10, 16368
    s_mov_b32 s82, 0xffff0000
    v_and_b32 v1, 15, v0
    v_lshrrev_b32 v2, 4, v0
    s_lshl_b32 s13, s3, 2
    v_add_u32 v9, s13, v2
    s_lshl_b32 s13, s7, 8
    s_lshl_b32 s14, s3, 5
    s_add_u32 s13, s13, s14
    v_lshrrev_b32 v3, 3, v0
    v_add_u32 v3, s13, v3
    v_mul_u32_u24 v3, 1280, v3
    v_and_b32 v4, 7, v0
    v_lshl_add_u32 v3, v4, 4, v3
    s_lshl_b32 s13, s8, 7
    v_add_u32 v3, s13, v3
    v_subrev_u32 v4, 10240, v3
    s_lshl_b32 s13, s8, 9
    v_lshl_add_u32 v5, v1, 5, s13
    v_mov_b32 v11, 0
    v_lshlrev_b32 v6, 4, v0
    s_waitcnt lgkmcnt(0)
    s_barrier
    s_mov_b32 s52, s18
    s_mov_b32 s53, s19
    s_mov_b32 s54, 0x280000
    s_mov_b32 s55, 0x20000
    s_mov_b32 s56, s20
    s_mov_b32 s57, s21
    s_mov_b32 s58, 0x280000
    s_mov_b32 s59, 0x20000
    global_load_dwordx4 v[54:57], v5, s[22:23] offset:0
    global_load_dwordx4 v[58:61], v5, s[22:23] offset:16
    v_mov_b32 v251, v3
    v_mov_b32 v252, v4
    v_lshlrev_b32 v3, 10, v2
    v_lshl_add_u32 v3, v1, 3, v3
    v_add_u32 v3, s10, v3
    s_mov_b32 s60, s24
    s_mov_b32 s61, s25
    s_mov_b32 s62, 0x280000
    s_mov_b32 s63, 0x20000
    s_mov_b32 s64, s16
    s_mov_b32 s65, s17
    s_mov_b32 s66, 0x280000
    s_mov_b32 s67, 0x20000
    s_mov_b32 s68, s50
    s_mov_b32 s69, s51
    s_mov_b32 s70, 0x10000000
    s_mov_b32 s71, 0x20000
    s_mov_b32 s72, s46
    s_mov_b32 s73, s47
    s_mov_b32 s74, 0xa00000
    s_mov_b32 s75, 0x20000
    s_mov_b32 s76, s48
    s_mov_b32 s77, s49
    s_mov_b32 s78, 0x100
    s_mov_b32 s79, 0x20000
    s_lshl_b32 s13, s9, 1
    s_and_b32 s13, s13, 0xfffffffc
    s_add_u32 s14, s26, s13
    s_addc_u32 s15, s27, 0
    s_load_dword s80, s[14:15], 0
    v_mov_b32 v12, 0
    v_mov_b32 v13, 0
    v_mov_b32 v14, 0
    v_mov_b32 v15, 0
    v_sub_u32 v8, 31, v9
    v_and_b32 v7, 7, v1
    v_xor_b32 v8, v8, v7
    v_lshlrev_b32 v8, 4, v8
    v_and_b32 v7, 1, v1
    v_lshl_add_u32 v8, v7, 11, v8
    v_lshrrev_b32 v7, 1, v1
    v_mul_u32_u24 v7, 20480, v7
    v_add_u32 v8, v8, v7
    v_lshrrev_b32 v7, 5, v0
    v_and_b32 v9, 31, v0
    s_lshl_b32 s14, s3, 1
    s_and_b32 s14, s14, 7
    v_xor_b32 v248, s14, v9
    v_lshlrev_b32 v248, 4, v248
    v_lshl_add_u32 v248, v7, 9, v248
    v_add_u32 v248, s10, v248
    v_xor_b32 v249, 16, v248
    v_lshlrev_b32 v250, 12, v7
    v_lshl_add_u32 v250, v9, 4, v250
    s_lshl_b32 s83, s8, 6
    s_lshl_b32 s14, s3, 3
    s_add_u32 s83, s83, s14
    s_lshl_b32 s83, s83, 12
    s_sub_u32 s14, 7, s7
    s_lshl_b32 s14, s14, 9
    s_add_u32 s83, s83, s14
    s_lshl_b32 s81, s8, 3
    s_add_u32 s81, s81, s3
    s_lshl_b32 s81, s81, 5
    s_add_u32 s81, s81, s7
    s_lshl_b32 s81, s81, 2
    s_add_u32 s81, s81, 0xc00000
    s_waitcnt lgkmcnt(0)
    s_bitcmp1_b32 s9, 0
    s_cselect_b32 s13, 0, 16
    s_lshl_b32 s80, s80, s13
    s_and_b32 s80, s80, 0xffff0000
    v_mov_b32 v224, -1
    v_mov_b32 v225, -1
    v_mov_b32 v226, -1
    v_mov_b32 v227, -1
    s_mov_b32 s13, s83
    buffer_store_dwordx4 v[224:227], v250, s[68:71], s13 offen sc1
    s_add_u32 s13, s13, 8192
    buffer_store_dwordx4 v[224:227], v250, s[68:71], s13 offen sc1
    s_add_u32 s13, s13, 8192
    buffer_store_dwordx4 v[224:227], v250, s[68:71], s13 offen sc1
    s_add_u32 s13, s13, 8192
    buffer_store_dwordx4 v[224:227], v250, s[68:71], s13 offen sc1
    v_lshrrev_b32 v4, 1, v0
    s_lshl_b32 s13, s3, 5
    v_add_u32 v4, s13, v4
    v_and_b32 v5, 1, v0
    v_mul_u32_u24 v244, 5120, v4
    v_lshl_add_u32 v244, v5, 3, v244
    s_lshl_b32 s13, s6, 4
    v_add_u32 v244, s13, v244
    v_mul_u32_u24 v245, 20480, v4
    v_lshl_add_u32 v245, v5, 4, v245
    v_mul_u32_u24 v7, 82048, v5
    v_lshl_add_u32 v246, v4, 4, v7
    s_sub_u32 s13, s5, 20
    s_mul_i32 s13, s13, 205
    v_add_u32 v4, s13, v4
    v_mul_u32_u24 v4, 1280, v4
    v_mul_u32_u24 v5, 156, v5
    s_mul_i32 s13, s4, 160
    v_add3_u32 v247, v4, v5, s13
    v_add_u32 v4, 1, v1
    v_and_b32 v5, 1, v4
    v_bfe_u32 v7, v4, 1, 1
    v_lshl_add_u32 v5, v5, 1, v7
    v_mul_u32_u24 v5, 4160, v5
    v_and_b32 v4, 28, v4
    v_lshl_add_u32 v5, v4, 1, v5
    v_lshl_add_u32 v5, v2, 4, v5
    v_add_u32 v240, s10, v5
    v_lshlrev_b32 v4, 5, v1
    v_sub_u32 v4, 480, v4
    v_lshl_add_u32 v5, v2, 4, v4
    v_add_u32 v241, s11, v5
    v_lshlrev_b32 v5, 3, v2
    v_sub_u32 v5, v4, v5
    v_add_u32 v5, 24, v5
    v_add_u32 v242, s11, v5
    v_lshlrev_b32 v4, 6, v1
    v_lshl_add_u32 v4, v2, 4, v4
    s_lshr_b32 s13, s3, 2
    s_lshl_b32 s13, s13, 7
    s_add_u32 s13, s13, s10
    v_add_u32 v243, s13, v4
    s_add_u32 s13, s11, 4096
    v_lshl_add_u32 v4, v2, 3, v1
    v_sub_u32 v4, 15, v4
    s_lshr_b32 s14, s80, 16
    v_mov_b32 v5, s14
    v_and_b32 v7, 1, v4
    v_lshlrev_b32 v7, 4, v7
    v_lshlrev_b32 v5, v7, v5
    v_ashrrev_i32 v4, 1, v4
    v_cmp_eq_u32 vcc, 0, v4
    s_nop 1
    v_cndmask_b32 v228, 0, v5, vcc
    v_cmp_eq_u32 vcc, 1, v4
    s_nop 1
    v_cndmask_b32 v229, 0, v5, vcc
    v_cmp_eq_u32 vcc, 2, v4
    s_nop 1
    v_cndmask_b32 v230, 0, v5, vcc
    v_cmp_eq_u32 vcc, 3, v4
    s_nop 1
    v_cndmask_b32 v231, 0, v5, vcc
    v_add_u32 v232, 3584, v241
    v_min_u32 v232, s13, v232
    v_add_u32 v233, 3648, v241
    v_min_u32 v233, s13, v233
    v_add_u32 v234, 3712, v241
    v_min_u32 v234, s13, v234
    v_add_u32 v235, 3776, v241
    v_min_u32 v235, s13, v235
    v_add_u32 v236, 3840, v241
    v_min_u32 v236, s13, v236
    v_add_u32 v237, 3904, v241
    v_min_u32 v237, s13, v237
    v_add_u32 v238, 3968, v241
    v_min_u32 v238, s13, v238
    v_add_u32 v239, 4032, v241
    v_min_u32 v239, s13, v239
    s_lshl_b32 s12, s9, 12
    s_waitcnt vmcnt(4)
    v_lshlrev_b32 v62, 16, v54
    v_and_b32 v66, s82, v54
    v_lshlrev_b32 v70, 16, v55
    v_and_b32 v74, s82, v55
    v_lshlrev_b32 v63, 16, v56
    v_and_b32 v67, s82, v56
    v_lshlrev_b32 v71, 16, v57
    v_and_b32 v75, s82, v57
    v_lshlrev_b32 v64, 16, v58
    v_and_b32 v68, s82, v58
    v_lshlrev_b32 v72, 16, v59
    v_and_b32 v76, s82, v59
    v_lshlrev_b32 v65, 16, v60
    v_and_b32 v69, s82, v60
    v_lshlrev_b32 v73, 16, v61
    v_and_b32 v77, s82, v61
    s_waitcnt vmcnt(0)
    buffer_load_dword v10, v11, s[76:79], 0 offen sc1
    s_waitcnt vmcnt(0)
    s_mov_b32 s15, 20000
Ltag_13:
    v_cmp_eq_u32 vcc, 0, v10
    s_cbranch_vccz Ltagd_14
    buffer_load_dword v10, v11, s[76:79], 0 offen sc1
    s_waitcnt vmcnt(0)
    s_sub_u32 s15, s15, 1
    s_cmp_lg_u32 s15, 0
    s_cbranch_scc1 Ltag_13
Ltagd_14:
    s_mov_b64 exec, 1
    buffer_store_dword v10, v11, s[68:71], s81 offen sc1
    s_mov_b64 exec, -1
    s_add_u32 m0, s10, 4160
    s_mov_b32 exec_lo, 0
    s_mov_b32 exec_hi, 0xffffff00
    buffer_load_dwordx4 v252, s[52:55], 0 offen lds
    s_mov_b64 exec, -1
    s_add_u32 m0, s10, 5184
    s_mov_b32 s13, 0
    buffer_load_dwordx4 v251, s[52:55], s13 offen offset:0 nt lds
    s_add_u32 s13, s13, 9216
    buffer_load_dwordx4 v251, s[52:55], s13 offen offset:1024 nt lds
    s_add_u32 s13, s13, 9216
    buffer_load_dwordx4 v251, s[52:55], s13 offen offset:2048 nt lds
    s_add_u32 s13, s13, 9216
    buffer_load_dwordx4 v251, s[52:55], s13 offen offset:3072 nt lds
    s_add_u32 m0, s10, 9280
    s_mov_b32 s13, 0
    buffer_load_dwordx4 v251, s[56:59], s13 offen offset:0 nt lds
    s_add_u32 s13, s13, 9216
    buffer_load_dwordx4 v251, s[56:59], s13 offen offset:1024 nt lds
    s_add_u32 s13, s13, 9216
    buffer_load_dwordx4 v251, s[56:59], s13 offen offset:2048 nt lds
    s_add_u32 s13, s13, 9216
    buffer_load_dwordx4 v251, s[56:59], s13 offen offset:3072 nt lds
    s_add_u32 m0, s10, 32
    s_waitcnt vmcnt(4)
    ds_read_b64 v[16:17], v3 offset:4800
    ds_read_b64 v[18:19], v3 offset:4928
    ds_read_b64 v[20:21], v3 offset:5056
    ds_read_b64 v[22:23], v3 offset:5184
    ds_read_b64 v[24:25], v3 offset:5312
    ds_read_b64 v[26:27], v3 offset:5440
    ds_read_b64 v[28:29], v3 offset:5568
    ds_read_b64 v[30:31], v3 offset:5696
    ds_read_b64 v[32:33], v3 offset:5824
    ds_read_b64 v[34:35], v3 offset:5952
    ds_read_b64 v[36:37], v3 offset:6080
    s_waitcnt lgkmcnt(0)
    v_lshlrev_b32 v78, 16, v16
    v_and_b32 v79, s82, v16
    v_lshlrev_b32 v80, 16, v18
    v_and_b32 v81, s82, v18
    v_lshlrev_b32 v82, 16, v20
    v_and_b32 v83, s82, v20
    v_lshlrev_b32 v84, 16, v22
    v_and_b32 v85, s82, v22
    v_lshlrev_b32 v86, 16, v24
    v_and_b32 v87, s82, v24
    v_lshlrev_b32 v88, 16, v26
    v_and_b32 v89, s82, v26
    v_lshlrev_b32 v90, 16, v28
    v_and_b32 v91, s82, v28
    v_lshlrev_b32 v92, 16, v30
    v_and_b32 v93, s82, v30
    v_lshlrev_b32 v94, 16, v32
    v_and_b32 v95, s82, v32
    v_lshlrev_b32 v96, 16, v34
    v_and_b32 v97, s82, v34
    v_lshlrev_b32 v98, 16, v36
    v_and_b32 v99, s82, v36
    v_pk_mul_f32 v[116:117], v[78:79], v[74:75]
    v_pk_mul_f32 v[118:119], v[80:81], v[74:75]
    v_pk_mul_f32 v[120:121], v[82:83], v[74:75]
    v_pk_mul_f32 v[122:123], v[84:85], v[74:75]
    v_pk_mul_f32 v[124:125], v[86:87], v[74:75]
    v_pk_mul_f32 v[126:127], v[88:89], v[74:75]
    v_pk_mul_f32 v[128:129], v[90:91], v[74:75]
    v_pk_mul_f32 v[130:131], v[92:93], v[74:75]
    v_pk_fma_f32 v[116:117], v[80:81], v[70:71], v[116:117]
    v_pk_fma_f32 v[118:119], v[82:83], v[70:71], v[118:119]
    v_pk_fma_f32 v[120:121], v[84:85], v[70:71], v[120:121]
    v_pk_fma_f32 v[122:123], v[86:87], v[70:71], v[122:123]
    v_pk_fma_f32 v[124:125], v[88:89], v[70:71], v[124:125]
    v_pk_fma_f32 v[126:127], v[90:91], v[70:71], v[126:127]
    v_pk_fma_f32 v[128:129], v[92:93], v[70:71], v[128:129]
    v_pk_fma_f32 v[130:131], v[94:95], v[70:71], v[130:131]
    v_pk_fma_f32 v[116:117], v[82:83], v[66:67], v[116:117]
    v_pk_fma_f32 v[118:119], v[84:85], v[66:67], v[118:119]
    v_pk_fma_f32 v[120:121], v[86:87], v[66:67], v[120:121]
    v_pk_fma_f32 v[122:123], v[88:89], v[66:67], v[122:123]
    v_pk_fma_f32 v[124:125], v[90:91], v[66:67], v[124:125]
    v_pk_fma_f32 v[126:127], v[92:93], v[66:67], v[126:127]
    v_pk_fma_f32 v[128:129], v[94:95], v[66:67], v[128:129]
    v_pk_fma_f32 v[130:131], v[96:97], v[66:67], v[130:131]
    v_pk_fma_f32 v[116:117], v[84:85], v[62:63], v[116:117]
    v_pk_fma_f32 v[118:119], v[86:87], v[62:63], v[118:119]
    v_pk_fma_f32 v[120:121], v[88:89], v[62:63], v[120:121]
    v_pk_fma_f32 v[122:123], v[90:91], v[62:63], v[122:123]
    v_pk_fma_f32 v[124:125], v[92:93], v[62:63], v[124:125]
    v_pk_fma_f32 v[126:127], v[94:95], v[62:63], v[126:127]
    v_pk_fma_f32 v[128:129], v[96:97], v[62:63], v[128:129]
    v_pk_fma_f32 v[130:131], v[98:99], v[62:63], v[130:131]
    v_lshlrev_b32 v78, 16, v17
    v_and_b32 v79, s82, v17
    v_lshlrev_b32 v80, 16, v19
    v_and_b32 v81, s82, v19
    v_lshlrev_b32 v82, 16, v21
    v_and_b32 v83, s82, v21
    v_lshlrev_b32 v84, 16, v23
    v_and_b32 v85, s82, v23
    v_lshlrev_b32 v86, 16, v25
    v_and_b32 v87, s82, v25
    v_lshlrev_b32 v88, 16, v27
    v_and_b32 v89, s82, v27
    v_lshlrev_b32 v90, 16, v29
    v_and_b32 v91, s82, v29
    v_lshlrev_b32 v92, 16, v31
    v_and_b32 v93, s82, v31
    v_lshlrev_b32 v94, 16, v33
    v_and_b32 v95, s82, v33
    v_lshlrev_b32 v96, 16, v35
    v_and_b32 v97, s82, v35
    v_lshlrev_b32 v98, 16, v37
    v_and_b32 v99, s82, v37
    v_pk_mul_f32 v[132:133], v[78:79], v[76:77]
    v_pk_mul_f32 v[134:135], v[80:81], v[76:77]
    v_pk_mul_f32 v[136:137], v[82:83], v[76:77]
    v_pk_mul_f32 v[138:139], v[84:85], v[76:77]
    v_pk_mul_f32 v[140:141], v[86:87], v[76:77]
    v_pk_mul_f32 v[142:143], v[88:89], v[76:77]
    v_pk_mul_f32 v[144:145], v[90:91], v[76:77]
    v_pk_mul_f32 v[146:147], v[92:93], v[76:77]
    v_pk_fma_f32 v[132:133], v[80:81], v[72:73], v[132:133]
    v_pk_fma_f32 v[134:135], v[82:83], v[72:73], v[134:135]
    v_pk_fma_f32 v[136:137], v[84:85], v[72:73], v[136:137]
    v_pk_fma_f32 v[138:139], v[86:87], v[72:73], v[138:139]
    v_pk_fma_f32 v[140:141], v[88:89], v[72:73], v[140:141]
    v_pk_fma_f32 v[142:143], v[90:91], v[72:73], v[142:143]
    v_pk_fma_f32 v[144:145], v[92:93], v[72:73], v[144:145]
    v_pk_fma_f32 v[146:147], v[94:95], v[72:73], v[146:147]
    v_pk_fma_f32 v[132:133], v[82:83], v[68:69], v[132:133]
    v_pk_fma_f32 v[134:135], v[84:85], v[68:69], v[134:135]
    v_pk_fma_f32 v[136:137], v[86:87], v[68:69], v[136:137]
    v_pk_fma_f32 v[138:139], v[88:89], v[68:69], v[138:139]
    v_pk_fma_f32 v[140:141], v[90:91], v[68:69], v[140:141]
    v_pk_fma_f32 v[142:143], v[92:93], v[68:69], v[142:143]
    v_pk_fma_f32 v[144:145], v[94:95], v[68:69], v[144:145]
    v_pk_fma_f32 v[146:147], v[96:97], v[68:69], v[146:147]
    v_pk_fma_f32 v[132:133], v[84:85], v[64:65], v[132:133]
    v_pk_fma_f32 v[134:135], v[86:87], v[64:65], v[134:135]
    v_pk_fma_f32 v[136:137], v[88:89], v[64:65], v[136:137]
    v_pk_fma_f32 v[138:139], v[90:91], v[64:65], v[138:139]
    v_pk_fma_f32 v[140:141], v[92:93], v[64:65], v[140:141]
    v_pk_fma_f32 v[142:143], v[94:95], v[64:65], v[142:143]
    v_pk_fma_f32 v[144:145], v[96:97], v[64:65], v[144:145]
    v_pk_fma_f32 v[146:147], v[98:99], v[64:65], v[146:147]
    s_waitcnt vmcnt(0)
    ds_read_b64 v[38:39], v3 offset:9280
    ds_read_b64 v[40:41], v3 offset:9408
    ds_read_b64 v[42:43], v3 offset:9536
    ds_read_b64 v[44:45], v3 offset:9664
    ds_read_b64 v[46:47], v3 offset:9792
    ds_read_b64 v[48:49], v3 offset:9920
    ds_read_b64 v[50:51], v3 offset:10048
    ds_read_b64 v[52:53], v3 offset:10176
    buffer_load_dwordx4 v6, s[60:63], s12 offen offset:0 nt lds
    buffer_load_dwordx4 v6, s[60:63], s12 offen offset:1024 nt lds
    buffer_load_dwordx4 v6, s[60:63], s12 offen offset:2048 nt lds
    buffer_load_dwordx4 v6, s[60:63], s12 offen offset:3072 nt lds
    s_waitcnt lgkmcnt(0)
    v_lshlrev_b32 v100, 16, v38
    v_and_b32 v101, s82, v38
    v_lshlrev_b32 v102, 16, v40
    v_and_b32 v103, s82, v40
    v_lshlrev_b32 v104, 16, v42
    v_and_b32 v105, s82, v42
    v_lshlrev_b32 v106, 16, v44
    v_and_b32 v107, s82, v44
    v_lshlrev_b32 v108, 16, v46
    v_and_b32 v109, s82, v46
    v_lshlrev_b32 v110, 16, v48
    v_and_b32 v111, s82, v48
    v_lshlrev_b32 v112, 16, v50
    v_and_b32 v113, s82, v50
    v_lshlrev_b32 v114, 16, v52
    v_and_b32 v115, s82, v52
    v_pk_mul_f32 v[116:117], v[116:117], v[100:101]
    v_pk_mul_f32 v[118:119], v[118:119], v[102:103]
    v_pk_mul_f32 v[120:121], v[120:121], v[104:105]
    v_pk_mul_f32 v[122:123], v[122:123], v[106:107]
    v_pk_mul_f32 v[124:125], v[124:125], v[108:109]
    v_pk_mul_f32 v[126:127], v[126:127], v[110:111]
    v_pk_mul_f32 v[128:129], v[128:129], v[112:113]
    v_pk_mul_f32 v[130:131], v[130:131], v[114:115]
    v_cvt_pk_bf16_f32 v148, v130, v128
    v_cvt_pk_bf16_f32 v149, v126, v124
    v_cvt_pk_bf16_f32 v150, v122, v120
    v_cvt_pk_bf16_f32 v151, v118, v116
    ds_write_b128 v8, v[148:151] offset:16384
    v_cvt_pk_bf16_f32 v152, v131, v129
    v_cvt_pk_bf16_f32 v153, v127, v125
    v_cvt_pk_bf16_f32 v154, v123, v121
    v_cvt_pk_bf16_f32 v155, v119, v117
    ds_write_b128 v8, v[152:155] offset:16896
    v_lshlrev_b32 v100, 16, v39
    v_and_b32 v101, s82, v39
    v_lshlrev_b32 v102, 16, v41
    v_and_b32 v103, s82, v41
    v_lshlrev_b32 v104, 16, v43
    v_and_b32 v105, s82, v43
    v_lshlrev_b32 v106, 16, v45
    v_and_b32 v107, s82, v45
    v_lshlrev_b32 v108, 16, v47
    v_and_b32 v109, s82, v47
    v_lshlrev_b32 v110, 16, v49
    v_and_b32 v111, s82, v49
    v_lshlrev_b32 v112, 16, v51
    v_and_b32 v113, s82, v51
    v_lshlrev_b32 v114, 16, v53
    v_and_b32 v115, s82, v53
    v_pk_mul_f32 v[132:133], v[132:133], v[100:101]
    v_pk_mul_f32 v[134:135], v[134:135], v[102:103]
    v_pk_mul_f32 v[136:137], v[136:137], v[104:105]
    v_pk_mul_f32 v[138:139], v[138:139], v[106:107]
    v_pk_mul_f32 v[140:141], v[140:141], v[108:109]
    v_pk_mul_f32 v[142:143], v[142:143], v[110:111]
    v_pk_mul_f32 v[144:145], v[144:145], v[112:113]
    v_pk_mul_f32 v[146:147], v[146:147], v[114:115]
    v_cvt_pk_bf16_f32 v156, v146, v144
    v_cvt_pk_bf16_f32 v157, v142, v140
    v_cvt_pk_bf16_f32 v158, v138, v136
    v_cvt_pk_bf16_f32 v159, v134, v132
    ds_write_b128 v8, v[156:159] offset:17408
    v_cvt_pk_bf16_f32 v160, v147, v145
    v_cvt_pk_bf16_f32 v161, v143, v141
    v_cvt_pk_bf16_f32 v162, v139, v137
    v_cvt_pk_bf16_f32 v163, v135, v133
    ds_write_b128 v8, v[160:163] offset:17920
    v_add_u32 v7, s10, v6
    v_and_b32 v3, 7, v0
    v_lshlrev_b32 v3, 2, v3
    s_lshl_b32 s13, s6, 7
    s_add_u32 s13, s13, 0xc00000
    s_waitcnt lgkmcnt(0)
    s_barrier
    ds_read_b128 v[16:19], v248 offset:16384
    ds_read_b128 v[20:23], v248 offset:17408
    ds_read_b128 v[24:27], v249 offset:18432
    ds_read_b128 v[28:31], v249 offset:19456
    s_waitcnt lgkmcnt(3)
    buffer_store_dwordx4 v[16:19], v250, s[68:71], s83 offen sc1
    s_add_u32 s83, s83, 8192
    s_waitcnt lgkmcnt(2)
    buffer_store_dwordx4 v[20:23], v250, s[68:71], s83 offen sc1
    s_add_u32 s83, s83, 8192
    s_waitcnt lgkmcnt(1)
    buffer_store_dwordx4 v[24:27], v250, s[68:71], s83 offen sc1
    s_add_u32 s83, s83, 8192
    s_waitcnt lgkmcnt(0)
    buffer_store_dwordx4 v[28:31], v250, s[68:71], s83 offen sc1
    buffer_load_dword v4, v3, s[68:71], s13 offen sc1
    s_waitcnt vmcnt(5)
    ds_read_b128 v[200:203], v7 offset:32
    ds_read_b64 v[204:205], v7 offset:48
    ds_read_b128 v[206:209], v7 offset:1056
    ds_read_b64 v[210:211], v7 offset:1072
    ds_read_b128 v[212:215], v7 offset:2080
    ds_read_b64 v[216:217], v7 offset:2096
    ds_read_b128 v[218:221], v7 offset:3104
    ds_read_b64 v[222:223], v7 offset:3120
    s_waitcnt lgkmcnt(6)
    v_mov_b32 v100, v201
    v_mov_b32 v101, v202
    v_mov_b32 v102, v203
    v_mov_b32 v103, v204
    ds_write_b128 v7, v[100:103] offset:4192
    v_alignbit_b32 v48, v201, v200, 16
    v_alignbit_b32 v49, v202, v201, 16
    v_alignbit_b32 v50, v203, v202, 16
    v_alignbit_b32 v51, v204, v203, 16
    v_mov_b32 v52, v49
    v_mov_b32 v53, v50
    v_mov_b32 v54, v51
    v_alignbit_b32 v55, v205, v204, 16
    ds_write_b128 v7, v[48:51] offset:8352
    ds_write_b128 v7, v[52:55] offset:12512
    s_waitcnt lgkmcnt(6)
    v_mov_b32 v104, v207
    v_mov_b32 v105, v208
    v_mov_b32 v106, v209
    v_mov_b32 v107, v210
    ds_write_b128 v7, v[104:107] offset:5216
    v_alignbit_b32 v56, v207, v206, 16
    v_alignbit_b32 v57, v208, v207, 16
    v_alignbit_b32 v58, v209, v208, 16
    v_alignbit_b32 v59, v210, v209, 16
    v_mov_b32 v60, v57
    v_mov_b32 v61, v58
    v_mov_b32 v62, v59
    v_alignbit_b32 v63, v211, v210, 16
    ds_write_b128 v7, v[56:59] offset:9376
    ds_write_b128 v7, v[60:63] offset:13536
    s_waitcnt lgkmcnt(6)
    v_mov_b32 v108, v213
    v_mov_b32 v109, v214
    v_mov_b32 v110, v215
    v_mov_b32 v111, v216
    ds_write_b128 v7, v[108:111] offset:6240
    v_alignbit_b32 v64, v213, v212, 16
    v_alignbit_b32 v65, v214, v213, 16
    v_alignbit_b32 v66, v215, v214, 16
    v_alignbit_b32 v67, v216, v215, 16
    v_mov_b32 v68, v65
    v_mov_b32 v69, v66
    v_mov_b32 v70, v67
    v_alignbit_b32 v71, v217, v216, 16
    ds_write_b128 v7, v[64:67] offset:10400
    ds_write_b128 v7, v[68:71] offset:14560
    s_waitcnt lgkmcnt(6)
    v_mov_b32 v112, v219
    v_mov_b32 v113, v220
    v_mov_b32 v114, v221
    v_mov_b32 v115, v222
    ds_write_b128 v7, v[112:115] offset:7264
    v_alignbit_b32 v72, v219, v218, 16
    v_alignbit_b32 v73, v220, v219, 16
    v_alignbit_b32 v74, v221, v220, 16
    v_alignbit_b32 v75, v222, v221, 16
    v_mov_b32 v76, v73
    v_mov_b32 v77, v74
    v_mov_b32 v78, v75
    v_alignbit_b32 v79, v223, v222, 16
    ds_write_b128 v7, v[72:75] offset:11424
    s_mov_b64 exec, 3
    v_lshlrev_b32 v96, 16, v200
    ds_write_b128 v7, v[12:15]
    ds_write_b128 v7, v[12:15] offset:4160
    ds_write_b128 v7, v[12:15] offset:8320
    ds_write_b128 v7, v[12:15] offset:12480
    s_mov_b64 exec, 1
    ds_write_b32 v7, v96 offset:8348
    ds_write_b32 v7, v200 offset:4188
    ds_write_b32 v7, v96 offset:12504
    ds_write_b32 v7, v48 offset:12508
    s_mov_b64 exec, -1
Lkb_16:
    ds_write_b128 v7, v[76:79] offset:15584
    s_mov_b64 exec, 1
    ds_write_b128 v7, v[12:15] offset:20464
    s_mov_b64 exec, -1
    ds_read_b64 v[168:169], v240 offset:3584
    ds_read_b64 v[170:171], v240 offset:3592
    ds_read_b64 v[172:173], v240 offset:3648
    ds_read_b64 v[174:175], v240 offset:3656
    ds_read_b64 v[176:177], v240 offset:3712
    ds_read_b64 v[178:179], v240 offset:3720
    ds_read_b64 v[180:181], v240 offset:3776
    ds_read_b64 v[182:183], v240 offset:3784
    ds_read_b64 v[184:185], v240 offset:3840
    ds_read_b64 v[186:187], v240 offset:3848
    ds_read_b64 v[188:189], v240 offset:3904
    ds_read_b64 v[190:191], v240 offset:3912
    ds_read_b64 v[192:193], v240 offset:3968
    ds_read_b64 v[194:195], v240 offset:3976
    ds_read_b64 v[196:197], v240 offset:4032
    ds_read_b64 v[198:199], v240 offset:4040
    s_mov_b32 s15, 20000
    s_mov_b32 m0, s11
    v_add_u32 v5, s11, v6
Lupoll_17:
    s_waitcnt vmcnt(0)
    v_cmp_ne_u32 vcc, v4, v10
    s_cbranch_vccz Ludone_18
    buffer_load_dword v4, v3, s[68:71], s13 offen sc1
    s_sub_u32 s15, s15, 1
    s_cmp_lg_u32 s15, 0
    s_cbranch_scc1 Lupoll_17
Ludone_18:
    s_waitcnt lgkmcnt(0)
    s_mov_b32 s15, 20000
    ds_read_b64 v[48:49], v240 offset:0
    ds_read_b64 v[50:51], v240 offset:8
    ds_read_b64 v[52:53], v240 offset:512
    ds_read_b64 v[54:55], v240 offset:520
    ds_read_b64 v[56:57], v240 offset:1024
    ds_read_b64 v[58:59], v240 offset:1032
    ds_read_b64 v[60:61], v240 offset:1536
    ds_read_b64 v[62:63], v240 offset:1544
    ds_read_b64 v[64:65], v240 offset:2048
    ds_read_b64 v[66:67], v240 offset:2056
    ds_read_b64 v[68:69], v240 offset:2560
    ds_read_b64 v[70:71], v240 offset:2568
    ds_read_b64 v[72:73], v240 offset:3072
    ds_read_b64 v[74:75], v240 offset:3080
    s_mov_b32 s14, 1310720
Luget_19:
    buffer_load_dwordx4 v6, s[68:71], s12 offen offset:0 sc1 lds
    buffer_load_dwordx4 v6, s[68:71], s12 offen offset:1024 sc1 lds
    buffer_load_dwordx4 v6, s[68:71], s12 offen offset:2048 sc1 lds
    buffer_load_dwordx4 v6, s[68:71], s12 offen offset:3072 sc1 lds
    s_waitcnt vmcnt(0)
    ds_read_b128 v[16:19], v5 offset:0
    ds_read_b128 v[20:23], v5 offset:1024
    ds_read_b128 v[24:27], v5 offset:2048
    ds_read_b128 v[28:31], v5 offset:3072
    s_waitcnt lgkmcnt(0)
    v_max3_u32 v16, v16, v17, v18
    v_max3_u32 v17, v19, v20, v21
    v_max3_u32 v18, v22, v23, v24
    v_max3_u32 v19, v25, v26, v27
    v_max3_u32 v20, v28, v29, v30
    v_max3_u32 v16, v16, v17, v18
    v_max3_u32 v19, v19, v20, v31
    v_max_u32 v16, v16, v19
    v_cmp_eq_u32 vcc, -1, v16
    s_cbranch_vccz Lugot_20
    s_sub_u32 s15, s15, 1
    s_cmp_lg_u32 s15, 0
    s_cbranch_scc1 Luget_19
Lugot_20:
    s_setprio 1
    s_cmp_ge_u32 s3, 4
    s_cbranch_scc1 LconvL_21
    s_setprio 2
    s_mov_b32 s15, 163840
    ds_read_b128 v[76:79], v232
    ds_read_b128 v[80:83], v241 offset:3072
    ds_read_b128 v[84:87], v241 offset:2560
    ds_read_b128 v[88:91], v241 offset:2048
    ds_read_b128 v[92:95], v241 offset:1536
    ds_read_b128 v[96:99], v241 offset:1024
    ds_read_b128 v[100:103], v241 offset:512
    ds_read_b128 v[104:107], v241 offset:0
    s_waitcnt lgkmcnt(0)
    v_mfma_f32_16x16x32_bf16 v[16:19], v[48:51], v[76:79], 0
    ds_read_b64 v[108:109], v240 offset:64
    v_mfma_f32_16x16x32_bf16 v[20:23], v[48:51], v[80:83], 0
    ds_read_b64 v[110:111], v240 offset:72
    v_mfma_f32_16x16x32_bf16 v[24:27], v[48:51], v[84:87], 0
    v_mfma_f32_16x16x32_bf16 v[28:31], v[48:51], v[88:91], 0
    ds_read_b128 v[136:139], v233
    v_mfma_f32_16x16x32_bf16 v[32:35], v[48:51], v[92:95], 0
    v_mfma_f32_16x16x32_bf16 v[36:39], v[48:51], v[96:99], 0
    ds_read_b128 v[140:143], v241 offset:3136
    v_mfma_f32_16x16x32_bf16 v[40:43], v[48:51], v[100:103], 0
    v_mfma_f32_16x16x32_bf16 v[44:47], v[48:51], v[104:107], 0
    ds_read_b128 v[144:147], v241 offset:2624
    v_mfma_f32_16x16x32_bf16 v[20:23], v[52:55], v[76:79], v[20:23]
    v_mfma_f32_16x16x32_bf16 v[24:27], v[52:55], v[80:83], v[24:27]
    ds_read_b128 v[148:151], v241 offset:2112
    v_mfma_f32_16x16x32_bf16 v[28:31], v[52:55], v[84:87], v[28:31]
    v_mfma_f32_16x16x32_bf16 v[32:35], v[52:55], v[88:91], v[32:35]
    ds_read_b128 v[152:155], v241 offset:1600
    v_mfma_f32_16x16x32_bf16 v[36:39], v[52:55], v[92:95], v[36:39]
    v_mfma_f32_16x16x32_bf16 v[40:43], v[52:55], v[96:99], v[40:43]
    ds_read_b128 v[156:159], v241 offset:1088
    v_mfma_f32_16x16x32_bf16 v[44:47], v[52:55], v[100:103], v[44:47]
    ds_read_b128 v[160:163], v241 offset:576
    v_mfma_f32_16x16x32_bf16 v[24:27], v[56:59], v[76:79], v[24:27]
    v_mfma_f32_16x16x32_bf16 v[28:31], v[56:59], v[80:83], v[28:31]
    ds_read_b128 v[164:167], v241 offset:64
    v_mfma_f32_16x16x32_bf16 v[32:35], v[56:59], v[84:87], v[32:35]
    v_mfma_f32_16x16x32_bf16 v[36:39], v[56:59], v[88:91], v[36:39]
    ds_read_b64 v[112:113], v240 offset:576
    v_mfma_f32_16x16x32_bf16 v[40:43], v[56:59], v[92:95], v[40:43]
    v_mfma_f32_16x16x32_bf16 v[44:47], v[56:59], v[96:99], v[44:47]
    ds_read_b64 v[114:115], v240 offset:584
    v_mfma_f32_16x16x32_bf16 v[28:31], v[60:63], v[76:79], v[28:31]
    v_mfma_f32_16x16x32_bf16 v[32:35], v[60:63], v[80:83], v[32:35]
    ds_read_b64 v[116:117], v240 offset:1088
    v_mfma_f32_16x16x32_bf16 v[36:39], v[60:63], v[84:87], v[36:39]
    v_mfma_f32_16x16x32_bf16 v[40:43], v[60:63], v[88:91], v[40:43]
    ds_read_b64 v[118:119], v240 offset:1096
    v_mfma_f32_16x16x32_bf16 v[44:47], v[60:63], v[92:95], v[44:47]
    v_mfma_f32_16x16x32_bf16 v[32:35], v[64:67], v[76:79], v[32:35]
    ds_read_b64 v[120:121], v240 offset:1600
    v_mfma_f32_16x16x32_bf16 v[36:39], v[64:67], v[80:83], v[36:39]
    ds_read_b64 v[122:123], v240 offset:1608
    v_mfma_f32_16x16x32_bf16 v[40:43], v[64:67], v[84:87], v[40:43]
    v_mfma_f32_16x16x32_bf16 v[44:47], v[64:67], v[88:91], v[44:47]
    ds_read_b64 v[124:125], v240 offset:2112
    v_mfma_f32_16x16x32_bf16 v[36:39], v[68:71], v[76:79], v[36:39]
    v_mfma_f32_16x16x32_bf16 v[40:43], v[68:71], v[80:83], v[40:43]
    ds_read_b64 v[126:127], v240 offset:2120
    v_mfma_f32_16x16x32_bf16 v[44:47], v[68:71], v[84:87], v[44:47]
    v_mfma_f32_16x16x32_bf16 v[40:43], v[72:75], v[76:79], v[40:43]
    ds_read_b64 v[128:129], v240 offset:2624
    v_mfma_f32_16x16x32_bf16 v[44:47], v[72:75], v[80:83], v[44:47]
    v_mfma_f32_16x16x32_bf16 v[44:47], v[168:171], v[76:79], v[44:47]
    ds_read_b64 v[130:131], v240 offset:2632
    v_mfma_f32_16x16x32_bf16 v[16:19], v[228:231], v[76:79], v[16:19]
    v_mfma_f32_16x16x32_bf16 v[20:23], v[228:231], v[80:83], v[20:23]
    ds_read_b64 v[132:133], v240 offset:3136
    v_mfma_f32_16x16x32_bf16 v[24:27], v[228:231], v[84:87], v[24:27]
    v_mfma_f32_16x16x32_bf16 v[28:31], v[228:231], v[88:91], v[28:31]
    ds_read_b64 v[134:135], v240 offset:3144
    v_mfma_f32_16x16x32_bf16 v[32:35], v[228:231], v[92:95], v[32:35]
    v_mfma_f32_16x16x32_bf16 v[36:39], v[228:231], v[96:99], v[36:39]
    v_mfma_f32_16x16x32_bf16 v[40:43], v[228:231], v[100:103], v[40:43]
    v_mfma_f32_16x16x32_bf16 v[44:47], v[228:231], v[104:107], v[44:47]
    s_waitcnt lgkmcnt(0)
    v_mfma_f32_16x16x32_bf16 v[16:19], v[108:111], v[136:139], v[16:19]
    ds_read_b64 v[48:49], v240 offset:128
    v_mfma_f32_16x16x32_bf16 v[20:23], v[108:111], v[140:143], v[20:23]
    ds_read_b64 v[50:51], v240 offset:136
    v_mfma_f32_16x16x32_bf16 v[24:27], v[108:111], v[144:147], v[24:27]
    v_mfma_f32_16x16x32_bf16 v[28:31], v[108:111], v[148:151], v[28:31]
    ds_read_b128 v[76:79], v234
    v_mfma_f32_16x16x32_bf16 v[32:35], v[108:111], v[152:155], v[32:35]
    ds_read_b128 v[80:83], v241 offset:3200
    v_mfma_f32_16x16x32_bf16 v[36:39], v[108:111], v[156:159], v[36:39]
    v_mfma_f32_16x16x32_bf16 v[40:43], v[108:111], v[160:163], v[40:43]
    ds_read_b128 v[84:87], v241 offset:2688
    v_mfma_f32_16x16x32_bf16 v[44:47], v[108:111], v[164:167], v[44:47]
    ds_read_b128 v[88:91], v241 offset:2176
    v_mfma_f32_16x16x32_bf16 v[20:23], v[112:115], v[136:139], v[20:23]
    v_mfma_f32_16x16x32_bf16 v[24:27], v[112:115], v[140:143], v[24:27]
    ds_read_b128 v[92:95], v241 offset:1664
    v_mfma_f32_16x16x32_bf16 v[28:31], v[112:115], v[144:147], v[28:31]
    ds_read_b128 v[96:99], v241 offset:1152
    v_mfma_f32_16x16x32_bf16 v[32:35], v[112:115], v[148:151], v[32:35]
    v_mfma_f32_16x16x32_bf16 v[36:39], v[112:115], v[152:155], v[36:39]
    ds_read_b128 v[100:103], v241 offset:640
    v_mfma_f32_16x16x32_bf16 v[40:43], v[112:115], v[156:159], v[40:43]
    ds_read_b128 v[104:107], v241 offset:128
    v_mfma_f32_16x16x32_bf16 v[44:47], v[112:115], v[160:163], v[44:47]
    v_mfma_f32_16x16x32_bf16 v[24:27], v[116:119], v[136:139], v[24:27]
    ds_read_b64 v[52:53], v240 offset:640
    v_mfma_f32_16x16x32_bf16 v[28:31], v[116:119], v[140:143], v[28:31]
    ds_read_b64 v[54:55], v240 offset:648
    v_mfma_f32_16x16x32_bf16 v[32:35], v[116:119], v[144:147], v[32:35]
    v_mfma_f32_16x16x32_bf16 v[36:39], v[116:119], v[148:151], v[36:39]
    ds_read_b64 v[56:57], v240 offset:1152
    v_mfma_f32_16x16x32_bf16 v[40:43], v[116:119], v[152:155], v[40:43]
    ds_read_b64 v[58:59], v240 offset:1160
    v_mfma_f32_16x16x32_bf16 v[44:47], v[116:119], v[156:159], v[44:47]
    v_mfma_f32_16x16x32_bf16 v[28:31], v[120:123], v[136:139], v[28:31]
    ds_read_b64 v[60:61], v240 offset:1664
    v_mfma_f32_16x16x32_bf16 v[32:35], v[120:123], v[140:143], v[32:35]
    ds_read_b64 v[62:63], v240 offset:1672
    v_mfma_f32_16x16x32_bf16 v[36:39], v[120:123], v[144:147], v[36:39]
    v_mfma_f32_16x16x32_bf16 v[40:43], v[120:123], v[148:151], v[40:43]
    ds_read_b64 v[64:65], v240 offset:2176
    v_mfma_f32_16x16x32_bf16 v[44:47], v[120:123], v[152:155], v[44:47]
    ds_read_b64 v[66:67], v240 offset:2184
    v_mfma_f32_16x16x32_bf16 v[32:35], v[124:127], v[136:139], v[32:35]
    v_mfma_f32_16x16x32_bf16 v[36:39], v[124:127], v[140:143], v[36:39]
    ds_read_b64 v[68:69], v240 offset:2688
    v_mfma_f32_16x16x32_bf16 v[40:43], v[124:127], v[144:147], v[40:43]
    ds_read_b64 v[70:71], v240 offset:2696
    v_mfma_f32_16x16x32_bf16 v[44:47], v[124:127], v[148:151], v[44:47]
    v_mfma_f32_16x16x32_bf16 v[36:39], v[128:131], v[136:139], v[36:39]
    ds_read_b64 v[72:73], v240 offset:3200
    v_mfma_f32_16x16x32_bf16 v[40:43], v[128:131], v[140:143], v[40:43]
    ds_read_b64 v[74:75], v240 offset:3208
    v_mfma_f32_16x16x32_bf16 v[44:47], v[128:131], v[144:147], v[44:47]
    v_mfma_f32_16x16x32_bf16 v[40:43], v[132:135], v[136:139], v[40:43]
    v_mfma_f32_16x16x32_bf16 v[44:47], v[132:135], v[140:143], v[44:47]
    v_mfma_f32_16x16x32_bf16 v[44:47], v[172:175], v[136:139], v[44:47]
    s_waitcnt lgkmcnt(0)
    v_mfma_f32_16x16x32_bf16 v[16:19], v[48:51], v[76:79], v[16:19]
    ds_read_b64 v[108:109], v240 offset:192
    v_mfma_f32_16x16x32_bf16 v[20:23], v[48:51], v[80:83], v[20:23]
    ds_read_b64 v[110:111], v240 offset:200
    v_mfma_f32_16x16x32_bf16 v[24:27], v[48:51], v[84:87], v[24:27]
    v_mfma_f32_16x16x32_bf16 v[28:31], v[48:51], v[88:91], v[28:31]
    ds_read_b128 v[136:139], v235
    v_mfma_f32_16x16x32_bf16 v[32:35], v[48:51], v[92:95], v[32:35]
    ds_read_b128 v[140:143], v241 offset:3264
    v_mfma_f32_16x16x32_bf16 v[36:39], v[48:51], v[96:99], v[36:39]
    v_mfma_f32_16x16x32_bf16 v[40:43], v[48:51], v[100:103], v[40:43]
    ds_read_b128 v[144:147], v241 offset:2752
    v_mfma_f32_16x16x32_bf16 v[44:47], v[48:51], v[104:107], v[44:47]
    ds_read_b128 v[148:151], v241 offset:2240
    v_mfma_f32_16x16x32_bf16 v[20:23], v[52:55], v[76:79], v[20:23]
    v_mfma_f32_16x16x32_bf16 v[24:27], v[52:55], v[80:83], v[24:27]
    ds_read_b128 v[152:155], v241 offset:1728
    v_mfma_f32_16x16x32_bf16 v[28:31], v[52:55], v[84:87], v[28:31]
    ds_read_b128 v[156:159], v241 offset:1216
    v_mfma_f32_16x16x32_bf16 v[32:35], v[52:55], v[88:91], v[32:35]
    v_mfma_f32_16x16x32_bf16 v[36:39], v[52:55], v[92:95], v[36:39]
    ds_read_b128 v[160:163], v241 offset:704
    v_mfma_f32_16x16x32_bf16 v[40:43], v[52:55], v[96:99], v[40:43]
    ds_read_b128 v[164:167], v241 offset:192
    v_mfma_f32_16x16x32_bf16 v[44:47], v[52:55], v[100:103], v[44:47]
    v_mfma_f32_16x16x32_bf16 v[24:27], v[56:59], v[76:79], v[24:27]
    ds_read_b64 v[112:113], v240 offset:704
    v_mfma_f32_16x16x32_bf16 v[28:31], v[56:59], v[80:83], v[28:31]
    ds_read_b64 v[114:115], v240 offset:712
    v_mfma_f32_16x16x32_bf16 v[32:35], v[56:59], v[84:87], v[32:35]
    v_mfma_f32_16x16x32_bf16 v[36:39], v[56:59], v[88:91], v[36:39]
    ds_read_b64 v[116:117], v240 offset:1216
    v_mfma_f32_16x16x32_bf16 v[40:43], v[56:59], v[92:95], v[40:43]
    ds_read_b64 v[118:119], v240 offset:1224
    v_mfma_f32_16x16x32_bf16 v[44:47], v[56:59], v[96:99], v[44:47]
    v_mfma_f32_16x16x32_bf16 v[28:31], v[60:63], v[76:79], v[28:31]
    ds_read_b64 v[120:121], v240 offset:1728
    v_mfma_f32_16x16x32_bf16 v[32:35], v[60:63], v[80:83], v[32:35]
    ds_read_b64 v[122:123], v240 offset:1736
    v_mfma_f32_16x16x32_bf16 v[36:39], v[60:63], v[84:87], v[36:39]
    v_mfma_f32_16x16x32_bf16 v[40:43], v[60:63], v[88:91], v[40:43]
    ds_read_b64 v[124:125], v240 offset:2240
    v_mfma_f32_16x16x32_bf16 v[44:47], v[60:63], v[92:95], v[44:47]
    ds_read_b64 v[126:127], v240 offset:2248
    v_mfma_f32_16x16x32_bf16 v[32:35], v[64:67], v[76:79], v[32:35]
    v_mfma_f32_16x16x32_bf16 v[36:39], v[64:67], v[80:83], v[36:39]
    ds_read_b64 v[128:129], v240 offset:2752
    v_mfma_f32_16x16x32_bf16 v[40:43], v[64:67], v[84:87], v[40:43]
    ds_read_b64 v[130:131], v240 offset:2760
    v_mfma_f32_16x16x32_bf16 v[44:47], v[64:67], v[88:91], v[44:47]
    v_mfma_f32_16x16x32_bf16 v[36:39], v[68:71], v[76:79], v[36:39]
    ds_read_b64 v[132:133], v240 offset:3264
    v_mfma_f32_16x16x32_bf16 v[40:43], v[68:71], v[80:83], v[40:43]
    ds_read_b64 v[134:135], v240 offset:3272
    v_mfma_f32_16x16x32_bf16 v[44:47], v[68:71], v[84:87], v[44:47]
    v_mfma_f32_16x16x32_bf16 v[40:43], v[72:75], v[76:79], v[40:43]
    v_mfma_f32_16x16x32_bf16 v[44:47], v[72:75], v[80:83], v[44:47]
    v_mfma_f32_16x16x32_bf16 v[44:47], v[176:179], v[76:79], v[44:47]
    s_waitcnt lgkmcnt(0)
    v_mfma_f32_16x16x32_bf16 v[16:19], v[108:111], v[136:139], v[16:19]
    ds_read_b64 v[48:49], v240 offset:256
    v_mfma_f32_16x16x32_bf16 v[20:23], v[108:111], v[140:143], v[20:23]
    ds_read_b64 v[50:51], v240 offset:264
    v_mfma_f32_16x16x32_bf16 v[24:27], v[108:111], v[144:147], v[24:27]
    v_mfma_f32_16x16x32_bf16 v[28:31], v[108:111], v[148:151], v[28:31]
    ds_read_b128 v[76:79], v236
    v_mfma_f32_16x16x32_bf16 v[32:35], v[108:111], v[152:155], v[32:35]
    ds_read_b128 v[80:83], v241 offset:3328
    v_mfma_f32_16x16x32_bf16 v[36:39], v[108:111], v[156:159], v[36:39]
    v_mfma_f32_16x16x32_bf16 v[40:43], v[108:111], v[160:163], v[40:43]
    ds_read_b128 v[84:87], v241 offset:2816
    v_mfma_f32_16x16x32_bf16 v[44:47], v[108:111], v[164:167], v[44:47]
    ds_read_b128 v[88:91], v241 offset:2304
    v_mfma_f32_16x16x32_bf16 v[20:23], v[112:115], v[136:139], v[20:23]
    v_mfma_f32_16x16x32_bf16 v[24:27], v[112:115], v[140:143], v[24:27]
    ds_read_b128 v[92:95], v241 offset:1792
    v_mfma_f32_16x16x32_bf16 v[28:31], v[112:115], v[144:147], v[28:31]
    ds_read_b128 v[96:99], v241 offset:1280
    v_mfma_f32_16x16x32_bf16 v[32:35], v[112:115], v[148:151], v[32:35]
    buffer_load_dword v4, v247, s[64:67], 0 offen
    v_mfma_f32_16x16x32_bf16 v[36:39], v[112:115], v[152:155], v[36:39]
    ds_read_b128 v[100:103], v241 offset:768
    v_mfma_f32_16x16x32_bf16 v[40:43], v[112:115], v[156:159], v[40:43]
    ds_read_b128 v[104:107], v241 offset:256
    v_mfma_f32_16x16x32_bf16 v[44:47], v[112:115], v[160:163], v[44:47]
    v_mfma_f32_16x16x32_bf16 v[24:27], v[116:119], v[136:139], v[24:27]
    ds_read_b64 v[52:53], v240 offset:768
    v_mfma_f32_16x16x32_bf16 v[28:31], v[116:119], v[140:143], v[28:31]
    ds_read_b64 v[54:55], v240 offset:776
    v_mfma_f32_16x16x32_bf16 v[32:35], v[116:119], v[144:147], v[32:35]
    v_mfma_f32_16x16x32_bf16 v[36:39], v[116:119], v[148:151], v[36:39]
    ds_read_b64 v[56:57], v240 offset:1280
    v_mfma_f32_16x16x32_bf16 v[40:43], v[116:119], v[152:155], v[40:43]
    ds_read_b64 v[58:59], v240 offset:1288
    v_mfma_f32_16x16x32_bf16 v[44:47], v[116:119], v[156:159], v[44:47]
    v_mfma_f32_16x16x32_bf16 v[28:31], v[120:123], v[136:139], v[28:31]
    ds_read_b64 v[60:61], v240 offset:1792
    v_mfma_f32_16x16x32_bf16 v[32:35], v[120:123], v[140:143], v[32:35]
    ds_read_b64 v[62:63], v240 offset:1800
    v_mfma_f32_16x16x32_bf16 v[36:39], v[120:123], v[144:147], v[36:39]
    v_mfma_f32_16x16x32_bf16 v[40:43], v[120:123], v[148:151], v[40:43]
    ds_read_b64 v[64:65], v240 offset:2304
    v_mfma_f32_16x16x32_bf16 v[44:47], v[120:123], v[152:155], v[44:47]
    ds_read_b64 v[66:67], v240 offset:2312
    v_mfma_f32_16x16x32_bf16 v[32:35], v[124:127], v[136:139], v[32:35]
    v_mfma_f32_16x16x32_bf16 v[36:39], v[124:127], v[140:143], v[36:39]
    ds_read_b64 v[68:69], v240 offset:2816
    buffer_load_dword v4, v247, s[64:67], s15 offen
    v_mfma_f32_16x16x32_bf16 v[40:43], v[124:127], v[144:147], v[40:43]
    ds_read_b64 v[70:71], v240 offset:2824
    v_mfma_f32_16x16x32_bf16 v[44:47], v[124:127], v[148:151], v[44:47]
    v_mfma_f32_16x16x32_bf16 v[36:39], v[128:131], v[136:139], v[36:39]
    ds_read_b64 v[72:73], v240 offset:3328
    v_mfma_f32_16x16x32_bf16 v[40:43], v[128:131], v[140:143], v[40:43]
    ds_read_b64 v[74:75], v240 offset:3336
    v_mfma_f32_16x16x32_bf16 v[44:47], v[128:131], v[144:147], v[44:47]
    v_mfma_f32_16x16x32_bf16 v[40:43], v[132:135], v[136:139], v[40:43]
    v_mfma_f32_16x16x32_bf16 v[44:47], v[132:135], v[140:143], v[44:47]
    v_mfma_f32_16x16x32_bf16 v[44:47], v[180:183], v[136:139], v[44:47]
    s_waitcnt lgkmcnt(0)
    v_mfma_f32_16x16x32_bf16 v[16:19], v[48:51], v[76:79], v[16:19]
    ds_read_b64 v[108:109], v240 offset:320
    v_mfma_f32_16x16x32_bf16 v[20:23], v[48:51], v[80:83], v[20:23]
    ds_read_b64 v[110:111], v240 offset:328
    v_mfma_f32_16x16x32_bf16 v[24:27], v[48:51], v[84:87], v[24:27]
    v_mfma_f32_16x16x32_bf16 v[28:31], v[48:51], v[88:91], v[28:31]
    ds_read_b128 v[136:139], v237
    v_mfma_f32_16x16x32_bf16 v[32:35], v[48:51], v[92:95], v[32:35]
    ds_read_b128 v[140:143], v241 offset:3392
    v_mfma_f32_16x16x32_bf16 v[36:39], v[48:51], v[96:99], v[36:39]
    v_mfma_f32_16x16x32_bf16 v[40:43], v[48:51], v[100:103], v[40:43]
    ds_read_b128 v[144:147], v241 offset:2880
    v_mfma_f32_16x16x32_bf16 v[44:47], v[48:51], v[104:107], v[44:47]
    ds_read_b128 v[148:151], v241 offset:2368
    v_mfma_f32_16x16x32_bf16 v[20:23], v[52:55], v[76:79], v[20:23]
    v_mfma_f32_16x16x32_bf16 v[24:27], v[52:55], v[80:83], v[24:27]
    ds_read_b128 v[152:155], v241 offset:1856
    v_mfma_f32_16x16x32_bf16 v[28:31], v[52:55], v[84:87], v[28:31]
    ds_read_b128 v[156:159], v241 offset:1344
    v_mfma_f32_16x16x32_bf16 v[32:35], v[52:55], v[88:91], v[32:35]
    v_mfma_f32_16x16x32_bf16 v[36:39], v[52:55], v[92:95], v[36:39]
    ds_read_b128 v[160:163], v241 offset:832
    v_mfma_f32_16x16x32_bf16 v[40:43], v[52:55], v[96:99], v[40:43]
    ds_read_b128 v[164:167], v241 offset:320
    v_mfma_f32_16x16x32_bf16 v[44:47], v[52:55], v[100:103], v[44:47]
    v_mfma_f32_16x16x32_bf16 v[24:27], v[56:59], v[76:79], v[24:27]
    ds_read_b64 v[112:113], v240 offset:832
    v_mfma_f32_16x16x32_bf16 v[28:31], v[56:59], v[80:83], v[28:31]
    ds_read_b64 v[114:115], v240 offset:840
    v_mfma_f32_16x16x32_bf16 v[32:35], v[56:59], v[84:87], v[32:35]
    v_mfma_f32_16x16x32_bf16 v[36:39], v[56:59], v[88:91], v[36:39]
    ds_read_b64 v[116:117], v240 offset:1344
    v_mfma_f32_16x16x32_bf16 v[40:43], v[56:59], v[92:95], v[40:43]
    ds_read_b64 v[118:119], v240 offset:1352
    v_mfma_f32_16x16x32_bf16 v[44:47], v[56:59], v[96:99], v[44:47]
    v_mfma_f32_16x16x32_bf16 v[28:31], v[60:63], v[76:79], v[28:31]
    ds_read_b64 v[120:121], v240 offset:1856
    v_mfma_f32_16x16x32_bf16 v[32:35], v[60:63], v[80:83], v[32:35]
    ds_read_b64 v[122:123], v240 offset:1864
    v_mfma_f32_16x16x32_bf16 v[36:39], v[60:63], v[84:87], v[36:39]
    v_mfma_f32_16x16x32_bf16 v[40:43], v[60:63], v[88:91], v[40:43]
    ds_read_b64 v[124:125], v240 offset:2368
    v_mfma_f32_16x16x32_bf16 v[44:47], v[60:63], v[92:95], v[44:47]
    ds_read_b64 v[126:127], v240 offset:2376
    v_mfma_f32_16x16x32_bf16 v[32:35], v[64:67], v[76:79], v[32:35]
    v_mfma_f32_16x16x32_bf16 v[36:39], v[64:67], v[80:83], v[36:39]
    ds_read_b64 v[128:129], v240 offset:2880
    v_mfma_f32_16x16x32_bf16 v[40:43], v[64:67], v[84:87], v[40:43]
    ds_read_b64 v[130:131], v240 offset:2888
    v_mfma_f32_16x16x32_bf16 v[44:47], v[64:67], v[88:91], v[44:47]
    v_mfma_f32_16x16x32_bf16 v[36:39], v[68:71], v[76:79], v[36:39]
    ds_read_b64 v[132:133], v240 offset:3392
    v_mfma_f32_16x16x32_bf16 v[40:43], v[68:71], v[80:83], v[40:43]
    ds_read_b64 v[134:135], v240 offset:3400
    v_mfma_f32_16x16x32_bf16 v[44:47], v[68:71], v[84:87], v[44:47]
    v_mfma_f32_16x16x32_bf16 v[40:43], v[72:75], v[76:79], v[40:43]
    v_mfma_f32_16x16x32_bf16 v[44:47], v[72:75], v[80:83], v[44:47]
    v_mfma_f32_16x16x32_bf16 v[44:47], v[184:187], v[76:79], v[44:47]
    s_waitcnt lgkmcnt(0)
    v_mfma_f32_16x16x32_bf16 v[16:19], v[108:111], v[136:139], v[16:19]
    ds_read_b64 v[48:49], v240 offset:384
    v_mfma_f32_16x16x32_bf16 v[20:23], v[108:111], v[140:143], v[20:23]
    ds_read_b64 v[50:51], v240 offset:392
    v_mfma_f32_16x16x32_bf16 v[24:27], v[108:111], v[144:147], v[24:27]
    v_mfma_f32_16x16x32_bf16 v[28:31], v[108:111], v[148:151], v[28:31]
    ds_read_b128 v[76:79], v238
    v_mfma_f32_16x16x32_bf16 v[32:35], v[108:111], v[152:155], v[32:35]
    ds_read_b128 v[80:83], v241 offset:3456
    v_mfma_f32_16x16x32_bf16 v[36:39], v[108:111], v[156:159], v[36:39]
    v_mfma_f32_16x16x32_bf16 v[40:43], v[108:111], v[160:163], v[40:43]
    ds_read_b128 v[84:87], v241 offset:2944
    v_mfma_f32_16x16x32_bf16 v[44:47], v[108:111], v[164:167], v[44:47]
    ds_read_b128 v[88:91], v241 offset:2432
    v_mfma_f32_16x16x32_bf16 v[20:23], v[112:115], v[136:139], v[20:23]
    v_mfma_f32_16x16x32_bf16 v[24:27], v[112:115], v[140:143], v[24:27]
    ds_read_b128 v[92:95], v241 offset:1920
    v_mfma_f32_16x16x32_bf16 v[28:31], v[112:115], v[144:147], v[28:31]
    ds_read_b128 v[96:99], v241 offset:1408
    v_mfma_f32_16x16x32_bf16 v[32:35], v[112:115], v[148:151], v[32:35]
    v_mfma_f32_16x16x32_bf16 v[36:39], v[112:115], v[152:155], v[36:39]
    ds_read_b128 v[100:103], v241 offset:896
    v_mfma_f32_16x16x32_bf16 v[40:43], v[112:115], v[156:159], v[40:43]
    ds_read_b128 v[104:107], v241 offset:384
    v_mfma_f32_16x16x32_bf16 v[44:47], v[112:115], v[160:163], v[44:47]
    v_mfma_f32_16x16x32_bf16 v[24:27], v[116:119], v[136:139], v[24:27]
    ds_read_b64 v[52:53], v240 offset:896
    v_mfma_f32_16x16x32_bf16 v[28:31], v[116:119], v[140:143], v[28:31]
    ds_read_b64 v[54:55], v240 offset:904
    v_mfma_f32_16x16x32_bf16 v[32:35], v[116:119], v[144:147], v[32:35]
    v_mfma_f32_16x16x32_bf16 v[36:39], v[116:119], v[148:151], v[36:39]
    ds_read_b64 v[56:57], v240 offset:1408
    v_mfma_f32_16x16x32_bf16 v[40:43], v[116:119], v[152:155], v[40:43]
    ds_read_b64 v[58:59], v240 offset:1416
    v_mfma_f32_16x16x32_bf16 v[44:47], v[116:119], v[156:159], v[44:47]
    v_mfma_f32_16x16x32_bf16 v[28:31], v[120:123], v[136:139], v[28:31]
    ds_read_b64 v[60:61], v240 offset:1920
    v_mfma_f32_16x16x32_bf16 v[32:35], v[120:123], v[140:143], v[32:35]
    ds_read_b64 v[62:63], v240 offset:1928
    v_mfma_f32_16x16x32_bf16 v[36:39], v[120:123], v[144:147], v[36:39]
    v_mfma_f32_16x16x32_bf16 v[40:43], v[120:123], v[148:151], v[40:43]
    ds_read_b64 v[64:65], v240 offset:2432
    v_mfma_f32_16x16x32_bf16 v[44:47], v[120:123], v[152:155], v[44:47]
    ds_read_b64 v[66:67], v240 offset:2440
    v_mfma_f32_16x16x32_bf16 v[32:35], v[124:127], v[136:139], v[32:35]
    v_mfma_f32_16x16x32_bf16 v[36:39], v[124:127], v[140:143], v[36:39]
    ds_read_b64 v[68:69], v240 offset:2944
    v_mfma_f32_16x16x32_bf16 v[40:43], v[124:127], v[144:147], v[40:43]
    ds_read_b64 v[70:71], v240 offset:2952
    v_mfma_f32_16x16x32_bf16 v[44:47], v[124:127], v[148:151], v[44:47]
    v_mfma_f32_16x16x32_bf16 v[36:39], v[128:131], v[136:139], v[36:39]
    ds_read_b64 v[72:73], v240 offset:3456
    v_mfma_f32_16x16x32_bf16 v[40:43], v[128:131], v[140:143], v[40:43]
    ds_read_b64 v[74:75], v240 offset:3464
    v_mfma_f32_16x16x32_bf16 v[44:47], v[128:131], v[144:147], v[44:47]
    v_mfma_f32_16x16x32_bf16 v[40:43], v[132:135], v[136:139], v[40:43]
    v_mfma_f32_16x16x32_bf16 v[44:47], v[132:135], v[140:143], v[44:47]
    v_mfma_f32_16x16x32_bf16 v[44:47], v[188:191], v[136:139], v[44:47]
    s_waitcnt lgkmcnt(0)
    v_mfma_f32_16x16x32_bf16 v[16:19], v[48:51], v[76:79], v[16:19]
    ds_read_b64 v[108:109], v240 offset:448
    v_mfma_f32_16x16x32_bf16 v[20:23], v[48:51], v[80:83], v[20:23]
    ds_read_b64 v[110:111], v240 offset:456
    v_mfma_f32_16x16x32_bf16 v[24:27], v[48:51], v[84:87], v[24:27]
    v_mfma_f32_16x16x32_bf16 v[28:31], v[48:51], v[88:91], v[28:31]
    ds_read_b128 v[136:139], v239
    v_mfma_f32_16x16x32_bf16 v[32:35], v[48:51], v[92:95], v[32:35]
    ds_read_b128 v[140:143], v241 offset:3520
    v_mfma_f32_16x16x32_bf16 v[36:39], v[48:51], v[96:99], v[36:39]
    v_mfma_f32_16x16x32_bf16 v[40:43], v[48:51], v[100:103], v[40:43]
    ds_read_b128 v[144:147], v241 offset:3008
    v_mfma_f32_16x16x32_bf16 v[44:47], v[48:51], v[104:107], v[44:47]
    ds_read_b128 v[148:151], v241 offset:2496
    v_mfma_f32_16x16x32_bf16 v[20:23], v[52:55], v[76:79], v[20:23]
    v_mfma_f32_16x16x32_bf16 v[24:27], v[52:55], v[80:83], v[24:27]
    ds_read_b128 v[152:155], v241 offset:1984
    v_mfma_f32_16x16x32_bf16 v[28:31], v[52:55], v[84:87], v[28:31]
    ds_read_b128 v[156:159], v241 offset:1472
    v_mfma_f32_16x16x32_bf16 v[32:35], v[52:55], v[88:91], v[32:35]
    v_mfma_f32_16x16x32_bf16 v[36:39], v[52:55], v[92:95], v[36:39]
    ds_read_b128 v[160:163], v241 offset:960
    v_mfma_f32_16x16x32_bf16 v[40:43], v[52:55], v[96:99], v[40:43]
    ds_read_b128 v[164:167], v241 offset:448
    v_mfma_f32_16x16x32_bf16 v[44:47], v[52:55], v[100:103], v[44:47]
    v_mfma_f32_16x16x32_bf16 v[24:27], v[56:59], v[76:79], v[24:27]
    ds_read_b64 v[112:113], v240 offset:960
    v_mfma_f32_16x16x32_bf16 v[28:31], v[56:59], v[80:83], v[28:31]
    ds_read_b64 v[114:115], v240 offset:968
    v_mfma_f32_16x16x32_bf16 v[32:35], v[56:59], v[84:87], v[32:35]
    v_mfma_f32_16x16x32_bf16 v[36:39], v[56:59], v[88:91], v[36:39]
    ds_read_b64 v[116:117], v240 offset:1472
    v_mfma_f32_16x16x32_bf16 v[40:43], v[56:59], v[92:95], v[40:43]
    ds_read_b64 v[118:119], v240 offset:1480
    v_mfma_f32_16x16x32_bf16 v[44:47], v[56:59], v[96:99], v[44:47]
    v_mfma_f32_16x16x32_bf16 v[28:31], v[60:63], v[76:79], v[28:31]
    ds_read_b64 v[120:121], v240 offset:1984
    v_mfma_f32_16x16x32_bf16 v[32:35], v[60:63], v[80:83], v[32:35]
    ds_read_b64 v[122:123], v240 offset:1992
    v_mfma_f32_16x16x32_bf16 v[36:39], v[60:63], v[84:87], v[36:39]
    v_mfma_f32_16x16x32_bf16 v[40:43], v[60:63], v[88:91], v[40:43]
    ds_read_b64 v[124:125], v240 offset:2496
    v_mfma_f32_16x16x32_bf16 v[44:47], v[60:63], v[92:95], v[44:47]
    ds_read_b64 v[126:127], v240 offset:2504
    v_mfma_f32_16x16x32_bf16 v[32:35], v[64:67], v[76:79], v[32:35]
    v_mfma_f32_16x16x32_bf16 v[36:39], v[64:67], v[80:83], v[36:39]
    ds_read_b64 v[128:129], v240 offset:3008
    v_mfma_f32_16x16x32_bf16 v[40:43], v[64:67], v[84:87], v[40:43]
    ds_read_b64 v[130:131], v240 offset:3016
    v_mfma_f32_16x16x32_bf16 v[44:47], v[64:67], v[88:91], v[44:47]
    v_mfma_f32_16x16x32_bf16 v[36:39], v[68:71], v[76:79], v[36:39]
    ds_read_b64 v[132:133], v240 offset:3520
    v_mfma_f32_16x16x32_bf16 v[40:43], v[68:71], v[80:83], v[40:43]
    ds_read_b64 v[134:135], v240 offset:3528
    v_mfma_f32_16x16x32_bf16 v[44:47], v[68:71], v[84:87], v[44:47]
    v_mfma_f32_16x16x32_bf16 v[40:43], v[72:75], v[76:79], v[40:43]
    v_mfma_f32_16x16x32_bf16 v[44:47], v[72:75], v[80:83], v[44:47]
    v_mfma_f32_16x16x32_bf16 v[44:47], v[192:195], v[76:79], v[44:47]
    s_waitcnt lgkmcnt(0)
    v_mfma_f32_16x16x32_bf16 v[16:19], v[108:111], v[136:139], v[16:19]
    v_mfma_f32_16x16x32_bf16 v[20:23], v[108:111], v[140:143], v[20:23]
    v_mfma_f32_16x16x32_bf16 v[20:23], v[112:115], v[136:139], v[20:23]
    v_mfma_f32_16x16x32_bf16 v[24:27], v[108:111], v[144:147], v[24:27]
    v_mfma_f32_16x16x32_bf16 v[24:27], v[112:115], v[140:143], v[24:27]
    v_mfma_f32_16x16x32_bf16 v[24:27], v[116:119], v[136:139], v[24:27]
    v_mfma_f32_16x16x32_bf16 v[28:31], v[108:111], v[148:151], v[28:31]
    v_mfma_f32_16x16x32_bf16 v[28:31], v[112:115], v[144:147], v[28:31]
    v_mfma_f32_16x16x32_bf16 v[28:31], v[116:119], v[140:143], v[28:31]
    ds_write_b128 v243, v[16:19] offset:0
    v_mfma_f32_16x16x32_bf16 v[28:31], v[120:123], v[136:139], v[28:31]
    v_mfma_f32_16x16x32_bf16 v[32:35], v[108:111], v[152:155], v[32:35]
    ds_write_b128 v243, v[20:23] offset:1024
    v_mfma_f32_16x16x32_bf16 v[32:35], v[112:115], v[148:151], v[32:35]
    v_mfma_f32_16x16x32_bf16 v[32:35], v[116:119], v[144:147], v[32:35]
    v_mfma_f32_16x16x32_bf16 v[32:35], v[120:123], v[140:143], v[32:35]
    ds_write_b128 v243, v[24:27] offset:2048
    v_mfma_f32_16x16x32_bf16 v[32:35], v[124:127], v[136:139], v[32:35]
    v_mfma_f32_16x16x32_bf16 v[36:39], v[108:111], v[156:159], v[36:39]
    v_mfma_f32_16x16x32_bf16 v[36:39], v[112:115], v[152:155], v[36:39]
    v_mfma_f32_16x16x32_bf16 v[36:39], v[116:119], v[148:151], v[36:39]
    ds_write_b128 v243, v[28:31] offset:3072
    v_mfma_f32_16x16x32_bf16 v[36:39], v[120:123], v[144:147], v[36:39]
    v_mfma_f32_16x16x32_bf16 v[36:39], v[124:127], v[140:143], v[36:39]
    v_mfma_f32_16x16x32_bf16 v[36:39], v[128:131], v[136:139], v[36:39]
    v_mfma_f32_16x16x32_bf16 v[40:43], v[108:111], v[160:163], v[40:43]
    v_mfma_f32_16x16x32_bf16 v[40:43], v[112:115], v[156:159], v[40:43]
    ds_write_b128 v243, v[32:35] offset:4096
    v_mfma_f32_16x16x32_bf16 v[40:43], v[116:119], v[152:155], v[40:43]
    v_mfma_f32_16x16x32_bf16 v[40:43], v[120:123], v[148:151], v[40:43]
    v_mfma_f32_16x16x32_bf16 v[40:43], v[124:127], v[144:147], v[40:43]
    v_mfma_f32_16x16x32_bf16 v[40:43], v[128:131], v[140:143], v[40:43]
    v_mfma_f32_16x16x32_bf16 v[40:43], v[132:135], v[136:139], v[40:43]
    v_mfma_f32_16x16x32_bf16 v[44:47], v[108:111], v[164:167], v[44:47]
    ds_write_b128 v243, v[36:39] offset:5120
    v_mfma_f32_16x16x32_bf16 v[44:47], v[112:115], v[160:163], v[44:47]
    v_mfma_f32_16x16x32_bf16 v[44:47], v[116:119], v[156:159], v[44:47]
    v_mfma_f32_16x16x32_bf16 v[44:47], v[120:123], v[152:155], v[44:47]
    v_mfma_f32_16x16x32_bf16 v[44:47], v[124:127], v[148:151], v[44:47]
    v_mfma_f32_16x16x32_bf16 v[44:47], v[128:131], v[144:147], v[44:47]
    v_mfma_f32_16x16x32_bf16 v[44:47], v[132:135], v[140:143], v[44:47]
    v_mfma_f32_16x16x32_bf16 v[44:47], v[196:199], v[136:139], v[44:47]
    ds_write_b128 v243, v[40:43] offset:6144
    s_nop 6
    ds_write_b128 v243, v[44:47] offset:7168
    s_setprio 0
    s_lshl_b32 s13, s3, 2
    s_add_u32 s13, s13, 155808
    v_mov_b32 v5, s13
    s_mov_b64 exec, 1
    ds_write_b32 v5, v10
    s_mov_b64 exec, -1
    s_mov_b32 s15, 655360
    buffer_load_dwordx2 v[208:209], v244, s[64:67], 0 offen offset:0
    buffer_load_dwordx2 v[210:211], v244, s[64:67], 0 offen offset:1280
    buffer_load_dwordx2 v[212:213], v244, s[64:67], 0 offen offset:2560
    buffer_load_dwordx2 v[214:215], v244, s[64:67], 0 offen offset:3840
    buffer_load_dwordx2 v[216:217], v244, s[64:67], s15 offen offset:0
    buffer_load_dwordx2 v[218:219], v244, s[64:67], s15 offen offset:1280
    buffer_load_dwordx2 v[220:221], v244, s[64:67], s15 offen offset:2560
    buffer_load_dwordx2 v[222:223], v244, s[64:67], s15 offen offset:3840
    buffer_load_dwordx2 v[200:201], v244, s[64:67], s14 offen offset:0
    buffer_load_dwordx2 v[202:203], v244, s[64:67], s14 offen offset:1280
    buffer_load_dwordx2 v[204:205], v244, s[64:67], s14 offen offset:2560
    buffer_load_dwordx2 v[206:207], v244, s[64:67], s14 offen offset:3840
    v_and_b32 v5, 7, v0
    v_lshlrev_b32 v5, 2, v5
    v_add_u32 v5, 155808, v5
    v_and_b32 v8, 1, v0
    v_mul_u32_u24 v8, 73728, v8
    v_sub_u32 v8, v246, v8
    v_add_u32 v9, 40960, v8
    s_waitcnt vmcnt(4)
    v_lshlrev_b32 v112, 16, v208
    v_and_b32 v113, s82, v208
    v_lshlrev_b32 v114, 16, v209
    v_and_b32 v115, s82, v209
    v_lshlrev_b32 v116, 16, v210
    v_and_b32 v117, s82, v210
    v_lshlrev_b32 v118, 16, v211
    v_and_b32 v119, s82, v211
    v_lshlrev_b32 v120, 16, v212
    v_and_b32 v121, s82, v212
    v_lshlrev_b32 v122, 16, v213
    v_and_b32 v123, s82, v213
    v_lshlrev_b32 v124, 16, v214
    v_and_b32 v125, s82, v214
    v_lshlrev_b32 v126, 16, v215
    v_and_b32 v127, s82, v215
    v_lshlrev_b32 v128, 16, v216
    v_and_b32 v129, s82, v216
    v_lshlrev_b32 v130, 16, v217
    v_and_b32 v131, s82, v217
    v_lshlrev_b32 v132, 16, v218
    v_and_b32 v133, s82, v218
    v_lshlrev_b32 v134, 16, v219
    v_and_b32 v135, s82, v219
    v_lshlrev_b32 v136, 16, v220
    v_and_b32 v137, s82, v220
    v_lshlrev_b32 v138, 16, v221
    v_and_b32 v139, s82, v221
    v_lshlrev_b32 v140, 16, v222
    v_and_b32 v141, s82, v222
    v_lshlrev_b32 v142, 16, v223
    v_and_b32 v143, s82, v223
    s_waitcnt vmcnt(0)
    v_add_u32 v4, 40960, v246
    v_lshlrev_b32 v48, 16, v200
    v_and_b32 v49, s82, v200
    v_lshlrev_b32 v50, 16, v201
    v_and_b32 v51, s82, v201
    v_lshlrev_b32 v52, 16, v202
    v_and_b32 v53, s82, v202
    v_lshlrev_b32 v54, 16, v203
    v_and_b32 v55, s82, v203
    v_lshlrev_b32 v56, 16, v204
    v_and_b32 v57, s82, v204
    v_lshlrev_b32 v58, 16, v205
    v_and_b32 v59, s82, v205
    v_lshlrev_b32 v60, 16, v206
    v_and_b32 v61, s82, v206
    v_lshlrev_b32 v62, 16, v207
    v_and_b32 v63, s82, v207
    s_mov_b32 s15, 320000
Lfw_23:
    ds_read_b32 v3, v5
    s_waitcnt lgkmcnt(0)
    v_cmp_ne_u32 vcc, v3, v10
    s_cbranch_vccz Lfwd_24
    s_sleep 2
    s_sub_u32 s15, s15, 1
    s_cmp_lg_u32 s15, 0
    s_cbranch_scc1 Lfw_23
Lfwd_24:
    ds_read_b128 v[72:75], v8 offset:0
    ds_read_b128 v[76:79], v8 offset:20480
    ds_read_b128 v[80:83], v9 offset:0
    ds_read_b128 v[84:87], v9 offset:20480
    ds_read_b128 v[88:91], v8 offset:2048
    ds_read_b128 v[92:95], v8 offset:22528
    ds_read_b128 v[96:99], v9 offset:2048
    ds_read_b128 v[100:103], v9 offset:22528
    s_lshl_b32 s13, s6, 5
    s_add_u32 s13, s13, 0
    s_waitcnt lgkmcnt(4)
    v_mul_f32 v112, v112, v72
    v_mul_f32 v113, v113, v76
    v_mul_f32 v114, v114, v80
    v_mul_f32 v115, v115, v84
    buffer_store_dwordx4 v[112:115], v245, s[72:75], s13 offen
    s_add_u32 s13, s13, 5120
    v_mul_f32 v116, v116, v73
    v_mul_f32 v117, v117, v77
    v_mul_f32 v118, v118, v81
    v_mul_f32 v119, v119, v85
    buffer_store_dwordx4 v[116:119], v245, s[72:75], s13 offen
    s_add_u32 s13, s13, 5120
    v_mul_f32 v120, v120, v74
    v_mul_f32 v121, v121, v78
    v_mul_f32 v122, v122, v82
    v_mul_f32 v123, v123, v86
    buffer_store_dwordx4 v[120:123], v245, s[72:75], s13 offen
    s_add_u32 s13, s13, 5120
    v_mul_f32 v124, v124, v75
    v_mul_f32 v125, v125, v79
    v_mul_f32 v126, v126, v83
    v_mul_f32 v127, v127, v87
    buffer_store_dwordx4 v[124:127], v245, s[72:75], s13 offen
    s_lshl_b32 s13, s6, 5
    s_add_u32 s13, s13, 2621440
    s_waitcnt lgkmcnt(0)
    v_mul_f32 v128, v128, v88
    v_mul_f32 v129, v129, v92
    v_mul_f32 v130, v130, v96
    v_mul_f32 v131, v131, v100
    buffer_store_dwordx4 v[128:131], v245, s[72:75], s13 offen
    s_add_u32 s13, s13, 5120
    v_mul_f32 v132, v132, v89
    v_mul_f32 v133, v133, v93
    v_mul_f32 v134, v134, v97
    v_mul_f32 v135, v135, v101
    buffer_store_dwordx4 v[132:135], v245, s[72:75], s13 offen
    s_add_u32 s13, s13, 5120
    v_mul_f32 v136, v136, v90
    v_mul_f32 v137, v137, v94
    v_mul_f32 v138, v138, v98
    v_mul_f32 v139, v139, v102
    buffer_store_dwordx4 v[136:139], v245, s[72:75], s13 offen
    s_add_u32 s13, s13, 5120
    v_mul_f32 v140, v140, v91
    v_mul_f32 v141, v141, v95
    v_mul_f32 v142, v142, v99
    v_mul_f32 v143, v143, v103
    buffer_store_dwordx4 v[140:143], v245, s[72:75], s13 offen
    s_branch Lfin_22
LconvL_21:
    ds_read_b128 v[76:79], v232
    ds_read_b128 v[80:83], v241 offset:3072
    ds_read_b128 v[84:87], v241 offset:2560
    ds_read_b128 v[88:91], v241 offset:2048
    s_waitcnt lgkmcnt(0)
    v_mfma_f32_16x16x32_bf16 v[16:19], v[48:51], v[76:79], 0
    ds_read_b64 v[108:109], v240 offset:64
    ds_read_b64 v[110:111], v240 offset:72
    v_mfma_f32_16x16x32_bf16 v[20:23], v[48:51], v[80:83], 0
    ds_read_b128 v[136:139], v233
    v_mfma_f32_16x16x32_bf16 v[24:27], v[48:51], v[84:87], 0
    ds_read_b128 v[140:143], v241 offset:3136
    v_mfma_f32_16x16x32_bf16 v[28:31], v[48:51], v[88:91], 0
    ds_read_b128 v[144:147], v241 offset:2624
    v_mfma_f32_16x16x32_bf16 v[20:23], v[52:55], v[76:79], v[20:23]
    ds_read_b128 v[148:151], v241 offset:2112
    v_mfma_f32_16x16x32_bf16 v[24:27], v[52:55], v[80:83], v[24:27]
    ds_read_b64 v[112:113], v240 offset:576
    v_mfma_f32_16x16x32_bf16 v[28:31], v[52:55], v[84:87], v[28:31]
    ds_read_b64 v[114:115], v240 offset:584
    v_mfma_f32_16x16x32_bf16 v[24:27], v[56:59], v[76:79], v[24:27]
    ds_read_b64 v[116:117], v240 offset:1088
    v_mfma_f32_16x16x32_bf16 v[28:31], v[56:59], v[80:83], v[28:31]
    ds_read_b64 v[118:119], v240 offset:1096
    v_mfma_f32_16x16x32_bf16 v[28:31], v[60:63], v[76:79], v[28:31]
    ds_read_b64 v[120:121], v240 offset:1600
    v_mfma_f32_16x16x32_bf16 v[16:19], v[228:231], v[76:79], v[16:19]
    ds_read_b64 v[122:123], v240 offset:1608
    v_mfma_f32_16x16x32_bf16 v[20:23], v[228:231], v[80:83], v[20:23]
    v_mfma_f32_16x16x32_bf16 v[24:27], v[228:231], v[84:87], v[24:27]
    v_mfma_f32_16x16x32_bf16 v[28:31], v[228:231], v[88:91], v[28:31]
    s_waitcnt lgkmcnt(0)
    v_mfma_f32_16x16x32_bf16 v[16:19], v[108:111], v[136:139], v[16:19]
    ds_read_b64 v[48:49], v240 offset:128
    ds_read_b64 v[50:51], v240 offset:136
    v_mfma_f32_16x16x32_bf16 v[20:23], v[108:111], v[140:143], v[20:23]
    ds_read_b128 v[76:79], v234
    ds_read_b128 v[80:83], v241 offset:3200
    v_mfma_f32_16x16x32_bf16 v[24:27], v[108:111], v[144:147], v[24:27]
    ds_read_b128 v[84:87], v241 offset:2688
    ds_read_b128 v[88:91], v241 offset:2176
    v_mfma_f32_16x16x32_bf16 v[28:31], v[108:111], v[148:151], v[28:31]
    ds_read_b64 v[52:53], v240 offset:640
    v_mfma_f32_16x16x32_bf16 v[20:23], v[112:115], v[136:139], v[20:23]
    ds_read_b64 v[54:55], v240 offset:648
    ds_read_b64 v[56:57], v240 offset:1152
    v_mfma_f32_16x16x32_bf16 v[24:27], v[112:115], v[140:143], v[24:27]
    ds_read_b64 v[58:59], v240 offset:1160
    ds_read_b64 v[60:61], v240 offset:1664
    v_mfma_f32_16x16x32_bf16 v[28:31], v[112:115], v[144:147], v[28:31]
    ds_read_b64 v[62:63], v240 offset:1672
    v_mfma_f32_16x16x32_bf16 v[24:27], v[116:119], v[136:139], v[24:27]
    v_mfma_f32_16x16x32_bf16 v[28:31], v[116:119], v[140:143], v[28:31]
    v_mfma_f32_16x16x32_bf16 v[28:31], v[120:123], v[136:139], v[28:31]
    s_waitcnt lgkmcnt(0)
    v_mfma_f32_16x16x32_bf16 v[16:19], v[48:51], v[76:79], v[16:19]
    ds_read_b64 v[108:109], v240 offset:192
    ds_read_b64 v[110:111], v240 offset:200
    v_mfma_f32_16x16x32_bf16 v[20:23], v[48:51], v[80:83], v[20:23]
    ds_read_b128 v[136:139], v235
    ds_read_b128 v[140:143], v241 offset:3264
    v_mfma_f32_16x16x32_bf16 v[24:27], v[48:51], v[84:87], v[24:27]
    ds_read_b128 v[144:147], v241 offset:2752
    ds_read_b128 v[148:151], v241 offset:2240
    v_mfma_f32_16x16x32_bf16 v[28:31], v[48:51], v[88:91], v[28:31]
    ds_read_b64 v[112:113], v240 offset:704
    v_mfma_f32_16x16x32_bf16 v[20:23], v[52:55], v[76:79], v[20:23]
    ds_read_b64 v[114:115], v240 offset:712
    ds_read_b64 v[116:117], v240 offset:1216
    v_mfma_f32_16x16x32_bf16 v[24:27], v[52:55], v[80:83], v[24:27]
    ds_read_b64 v[118:119], v240 offset:1224
    ds_read_b64 v[120:121], v240 offset:1728
    v_mfma_f32_16x16x32_bf16 v[28:31], v[52:55], v[84:87], v[28:31]
    ds_read_b64 v[122:123], v240 offset:1736
    v_mfma_f32_16x16x32_bf16 v[24:27], v[56:59], v[76:79], v[24:27]
    v_mfma_f32_16x16x32_bf16 v[28:31], v[56:59], v[80:83], v[28:31]
    v_mfma_f32_16x16x32_bf16 v[28:31], v[60:63], v[76:79], v[28:31]
    s_waitcnt lgkmcnt(0)
    v_mfma_f32_16x16x32_bf16 v[16:19], v[108:111], v[136:139], v[16:19]
    ds_read_b64 v[48:49], v240 offset:256
    ds_read_b64 v[50:51], v240 offset:264
    v_mfma_f32_16x16x32_bf16 v[20:23], v[108:111], v[140:143], v[20:23]
    ds_read_b128 v[76:79], v236
    ds_read_b128 v[80:83], v241 offset:3328
    v_mfma_f32_16x16x32_bf16 v[24:27], v[108:111], v[144:147], v[24:27]
    ds_read_b128 v[84:87], v241 offset:2816
    ds_read_b128 v[88:91], v241 offset:2304
    v_mfma_f32_16x16x32_bf16 v[28:31], v[108:111], v[148:151], v[28:31]
    ds_read_b64 v[52:53], v240 offset:768
    v_mfma_f32_16x16x32_bf16 v[20:23], v[112:115], v[136:139], v[20:23]
    ds_read_b64 v[54:55], v240 offset:776
    ds_read_b64 v[56:57], v240 offset:1280
    v_mfma_f32_16x16x32_bf16 v[24:27], v[112:115], v[140:143], v[24:27]
    ds_read_b64 v[58:59], v240 offset:1288
    ds_read_b64 v[60:61], v240 offset:1792
    v_mfma_f32_16x16x32_bf16 v[28:31], v[112:115], v[144:147], v[28:31]
    ds_read_b64 v[62:63], v240 offset:1800
    v_mfma_f32_16x16x32_bf16 v[24:27], v[116:119], v[136:139], v[24:27]
    v_mfma_f32_16x16x32_bf16 v[28:31], v[116:119], v[140:143], v[28:31]
    v_mfma_f32_16x16x32_bf16 v[28:31], v[120:123], v[136:139], v[28:31]
    s_waitcnt lgkmcnt(0)
    v_mfma_f32_16x16x32_bf16 v[16:19], v[48:51], v[76:79], v[16:19]
    ds_read_b64 v[108:109], v240 offset:320
    ds_read_b64 v[110:111], v240 offset:328
    v_mfma_f32_16x16x32_bf16 v[20:23], v[48:51], v[80:83], v[20:23]
    ds_read_b128 v[136:139], v237
    ds_read_b128 v[140:143], v241 offset:3392
    v_mfma_f32_16x16x32_bf16 v[24:27], v[48:51], v[84:87], v[24:27]
    ds_read_b128 v[144:147], v241 offset:2880
    ds_read_b128 v[148:151], v241 offset:2368
    v_mfma_f32_16x16x32_bf16 v[28:31], v[48:51], v[88:91], v[28:31]
    ds_read_b64 v[112:113], v240 offset:832
    v_mfma_f32_16x16x32_bf16 v[20:23], v[52:55], v[76:79], v[20:23]
    ds_read_b64 v[114:115], v240 offset:840
    ds_read_b64 v[116:117], v240 offset:1344
    v_mfma_f32_16x16x32_bf16 v[24:27], v[52:55], v[80:83], v[24:27]
    ds_read_b64 v[118:119], v240 offset:1352
    ds_read_b64 v[120:121], v240 offset:1856
    v_mfma_f32_16x16x32_bf16 v[28:31], v[52:55], v[84:87], v[28:31]
    ds_read_b64 v[122:123], v240 offset:1864
    v_mfma_f32_16x16x32_bf16 v[24:27], v[56:59], v[76:79], v[24:27]
    v_mfma_f32_16x16x32_bf16 v[28:31], v[56:59], v[80:83], v[28:31]
    v_mfma_f32_16x16x32_bf16 v[28:31], v[60:63], v[76:79], v[28:31]
    s_waitcnt lgkmcnt(0)
    v_mfma_f32_16x16x32_bf16 v[16:19], v[108:111], v[136:139], v[16:19]
    ds_read_b64 v[48:49], v240 offset:384
    ds_read_b64 v[50:51], v240 offset:392
    v_mfma_f32_16x16x32_bf16 v[20:23], v[108:111], v[140:143], v[20:23]
    ds_read_b128 v[76:79], v238
    ds_read_b128 v[80:83], v241 offset:3456
    v_mfma_f32_16x16x32_bf16 v[24:27], v[108:111], v[144:147], v[24:27]
    ds_read_b128 v[84:87], v241 offset:2944
    ds_read_b128 v[88:91], v241 offset:2432
    v_mfma_f32_16x16x32_bf16 v[28:31], v[108:111], v[148:151], v[28:31]
    ds_read_b64 v[52:53], v240 offset:896
    v_mfma_f32_16x16x32_bf16 v[20:23], v[112:115], v[136:139], v[20:23]
    ds_read_b64 v[54:55], v240 offset:904
    ds_read_b64 v[56:57], v240 offset:1408
    v_mfma_f32_16x16x32_bf16 v[24:27], v[112:115], v[140:143], v[24:27]
    ds_read_b64 v[58:59], v240 offset:1416
    ds_read_b64 v[60:61], v240 offset:1920
    v_mfma_f32_16x16x32_bf16 v[28:31], v[112:115], v[144:147], v[28:31]
    ds_read_b64 v[62:63], v240 offset:1928
    v_mfma_f32_16x16x32_bf16 v[24:27], v[116:119], v[136:139], v[24:27]
    v_mfma_f32_16x16x32_bf16 v[28:31], v[116:119], v[140:143], v[28:31]
    v_mfma_f32_16x16x32_bf16 v[28:31], v[120:123], v[136:139], v[28:31]
    s_waitcnt lgkmcnt(0)
    v_mfma_f32_16x16x32_bf16 v[16:19], v[48:51], v[76:79], v[16:19]
    ds_read_b64 v[108:109], v240 offset:448
    ds_read_b64 v[110:111], v240 offset:456
    v_mfma_f32_16x16x32_bf16 v[20:23], v[48:51], v[80:83], v[20:23]
    ds_read_b128 v[136:139], v239
    ds_read_b128 v[140:143], v241 offset:3520
    v_mfma_f32_16x16x32_bf16 v[24:27], v[48:51], v[84:87], v[24:27]
    ds_read_b128 v[144:147], v241 offset:3008
    ds_read_b128 v[148:151], v241 offset:2496
    v_mfma_f32_16x16x32_bf16 v[28:31], v[48:51], v[88:91], v[28:31]
    ds_read_b64 v[112:113], v240 offset:960
    v_mfma_f32_16x16x32_bf16 v[20:23], v[52:55], v[76:79], v[20:23]
    ds_read_b64 v[114:115], v240 offset:968
    ds_read_b64 v[116:117], v240 offset:1472
    v_mfma_f32_16x16x32_bf16 v[24:27], v[52:55], v[80:83], v[24:27]
    ds_read_b64 v[118:119], v240 offset:1480
    ds_read_b64 v[120:121], v240 offset:1984
    v_mfma_f32_16x16x32_bf16 v[28:31], v[52:55], v[84:87], v[28:31]
    ds_read_b64 v[122:123], v240 offset:1992
    v_mfma_f32_16x16x32_bf16 v[24:27], v[56:59], v[76:79], v[24:27]
    v_mfma_f32_16x16x32_bf16 v[28:31], v[56:59], v[80:83], v[28:31]
    v_mfma_f32_16x16x32_bf16 v[28:31], v[60:63], v[76:79], v[28:31]
    s_waitcnt lgkmcnt(0)
    v_mfma_f32_16x16x32_bf16 v[16:19], v[108:111], v[136:139], v[16:19]
    v_mfma_f32_16x16x32_bf16 v[20:23], v[108:111], v[140:143], v[20:23]
    v_mfma_f32_16x16x32_bf16 v[20:23], v[112:115], v[136:139], v[20:23]
    v_mfma_f32_16x16x32_bf16 v[24:27], v[108:111], v[144:147], v[24:27]
    v_mfma_f32_16x16x32_bf16 v[24:27], v[112:115], v[140:143], v[24:27]
    v_mfma_f32_16x16x32_bf16 v[24:27], v[116:119], v[136:139], v[24:27]
    v_mfma_f32_16x16x32_bf16 v[28:31], v[108:111], v[148:151], v[28:31]
    v_mfma_f32_16x16x32_bf16 v[28:31], v[112:115], v[144:147], v[28:31]
    v_mfma_f32_16x16x32_bf16 v[28:31], v[116:119], v[140:143], v[28:31]
    v_mfma_f32_16x16x32_bf16 v[28:31], v[120:123], v[136:139], v[28:31]
    s_lshl_b32 s13, s3, 2
    s_add_u32 s13, s13, 155792
    v_mov_b32 v5, s13
    v_subrev_u32 v8, 73728, v243
    s_mov_b32 s15, 320000
Lfw_25:
    ds_read_b32 v3, v5
    s_waitcnt lgkmcnt(0)
    v_cmp_ne_u32 vcc, v3, v10
    s_cbranch_vccz Lfwd_26
    s_sleep 2
    s_sub_u32 s15, s15, 1
    s_cmp_lg_u32 s15, 0
    s_cbranch_scc1 Lfw_25
Lfwd_26:
    ds_write_b128 v8, v[16:19] offset:0
    ds_write_b128 v8, v[20:23] offset:1024
    ds_write_b128 v8, v[24:27] offset:2048
    ds_write_b128 v8, v[28:31] offset:3072
    s_lshl_b32 s13, s3, 2
    s_add_u32 s13, s13, 155808
    v_mov_b32 v5, s13
    s_mov_b64 exec, 1
    ds_write_b32 v5, v10
    s_mov_b64 exec, -1
    ds_read_b64 v[48:49], v240 offset:0
    ds_read_b64 v[50:51], v240 offset:8
    ds_read_b64 v[52:53], v240 offset:512
    ds_read_b64 v[54:55], v240 offset:520
    ds_read_b64 v[56:57], v240 offset:1024
    ds_read_b64 v[58:59], v240 offset:1032
    ds_read_b64 v[60:61], v240 offset:1536
    ds_read_b64 v[62:63], v240 offset:1544
    ds_read_b64 v[64:65], v240 offset:2048
    ds_read_b64 v[66:67], v240 offset:2056
    ds_read_b64 v[68:69], v240 offset:2560
    ds_read_b64 v[70:71], v240 offset:2568
    ds_read_b64 v[72:73], v240 offset:3072
    ds_read_b64 v[74:75], v240 offset:3080
    ds_read_b128 v[76:79], v232
    ds_read_b128 v[80:83], v241 offset:3072
    ds_read_b128 v[84:87], v241 offset:2560
    ds_read_b128 v[88:91], v241 offset:2048
    ds_read_b128 v[92:95], v241 offset:1536
    ds_read_b128 v[96:99], v241 offset:1024
    ds_read_b128 v[100:103], v241 offset:512
    ds_read_b128 v[104:107], v241 offset:0
    s_waitcnt lgkmcnt(0)
    v_mfma_f32_16x16x32_bf16 v[32:35], v[48:51], v[92:95], 0
    ds_read_b64 v[108:109], v240 offset:64
    v_mfma_f32_16x16x32_bf16 v[36:39], v[48:51], v[96:99], 0
    ds_read_b64 v[110:111], v240 offset:72
    v_mfma_f32_16x16x32_bf16 v[40:43], v[48:51], v[100:103], 0
    ds_read_b128 v[136:139], v233
    v_mfma_f32_16x16x32_bf16 v[44:47], v[48:51], v[104:107], 0
    ds_read_b128 v[140:143], v241 offset:3136
    v_mfma_f32_16x16x32_bf16 v[32:35], v[52:55], v[88:91], v[32:35]
    ds_read_b128 v[144:147], v241 offset:2624
    v_mfma_f32_16x16x32_bf16 v[36:39], v[52:55], v[92:95], v[36:39]
    v_mfma_f32_16x16x32_bf16 v[40:43], v[52:55], v[96:99], v[40:43]
    ds_read_b128 v[148:151], v241 offset:2112
    v_mfma_f32_16x16x32_bf16 v[44:47], v[52:55], v[100:103], v[44:47]
    ds_read_b128 v[152:155], v241 offset:1600
    v_mfma_f32_16x16x32_bf16 v[32:35], v[56:59], v[84:87], v[32:35]
    ds_read_b128 v[156:159], v241 offset:1088
    v_mfma_f32_16x16x32_bf16 v[36:39], v[56:59], v[88:91], v[36:39]
    ds_read_b128 v[160:163], v241 offset:576
    v_mfma_f32_16x16x32_bf16 v[40:43], v[56:59], v[92:95], v[40:43]
    v_mfma_f32_16x16x32_bf16 v[44:47], v[56:59], v[96:99], v[44:47]
    ds_read_b128 v[164:167], v241 offset:64
    v_mfma_f32_16x16x32_bf16 v[32:35], v[60:63], v[80:83], v[32:35]
    ds_read_b64 v[112:113], v240 offset:576
    v_mfma_f32_16x16x32_bf16 v[36:39], v[60:63], v[84:87], v[36:39]
    ds_read_b64 v[114:115], v240 offset:584
    v_mfma_f32_16x16x32_bf16 v[40:43], v[60:63], v[88:91], v[40:43]
    ds_read_b64 v[116:117], v240 offset:1088
    v_mfma_f32_16x16x32_bf16 v[44:47], v[60:63], v[92:95], v[44:47]
    ds_read_b64 v[118:119], v240 offset:1096
    v_mfma_f32_16x16x32_bf16 v[32:35], v[64:67], v[76:79], v[32:35]
    v_mfma_f32_16x16x32_bf16 v[36:39], v[64:67], v[80:83], v[36:39]
    ds_read_b64 v[120:121], v240 offset:1600
    v_mfma_f32_16x16x32_bf16 v[40:43], v[64:67], v[84:87], v[40:43]
    ds_read_b64 v[122:123], v240 offset:1608
    v_mfma_f32_16x16x32_bf16 v[44:47], v[64:67], v[88:91], v[44:47]
    ds_read_b64 v[124:125], v240 offset:2112
    v_mfma_f32_16x16x32_bf16 v[36:39], v[68:71], v[76:79], v[36:39]
    ds_read_b64 v[126:127], v240 offset:2120
    v_mfma_f32_16x16x32_bf16 v[40:43], v[68:71], v[80:83], v[40:43]
    v_mfma_f32_16x16x32_bf16 v[44:47], v[68:71], v[84:87], v[44:47]
    ds_read_b64 v[128:129], v240 offset:2624
    v_mfma_f32_16x16x32_bf16 v[40:43], v[72:75], v[76:79], v[40:43]
    ds_read_b64 v[130:131], v240 offset:2632
    v_mfma_f32_16x16x32_bf16 v[44:47], v[72:75], v[80:83], v[44:47]
    ds_read_b64 v[132:133], v240 offset:3136
    v_mfma_f32_16x16x32_bf16 v[44:47], v[168:171], v[76:79], v[44:47]
    ds_read_b64 v[134:135], v240 offset:3144
    v_mfma_f32_16x16x32_bf16 v[32:35], v[228:231], v[92:95], v[32:35]
    v_mfma_f32_16x16x32_bf16 v[36:39], v[228:231], v[96:99], v[36:39]
    v_mfma_f32_16x16x32_bf16 v[40:43], v[228:231], v[100:103], v[40:43]
    v_mfma_f32_16x16x32_bf16 v[44:47], v[228:231], v[104:107], v[44:47]
    s_waitcnt lgkmcnt(0)
    v_mfma_f32_16x16x32_bf16 v[32:35], v[108:111], v[152:155], v[32:35]
    ds_read_b64 v[48:49], v240 offset:128
    v_mfma_f32_16x16x32_bf16 v[36:39], v[108:111], v[156:159], v[36:39]
    ds_read_b64 v[50:51], v240 offset:136
    v_mfma_f32_16x16x32_bf16 v[40:43], v[108:111], v[160:163], v[40:43]
    ds_read_b128 v[76:79], v234
    v_mfma_f32_16x16x32_bf16 v[44:47], v[108:111], v[164:167], v[44:47]
    ds_read_b128 v[80:83], v241 offset:3200
    v_mfma_f32_16x16x32_bf16 v[32:35], v[112:115], v[148:151], v[32:35]
    ds_read_b128 v[84:87], v241 offset:2688
    v_mfma_f32_16x16x32_bf16 v[36:39], v[112:115], v[152:155], v[36:39]
    ds_read_b128 v[88:91], v241 offset:2176
    v_mfma_f32_16x16x32_bf16 v[40:43], v[112:115], v[156:159], v[40:43]
    ds_read_b128 v[92:95], v241 offset:1664
    v_mfma_f32_16x16x32_bf16 v[44:47], v[112:115], v[160:163], v[44:47]
    ds_read_b128 v[96:99], v241 offset:1152
    v_mfma_f32_16x16x32_bf16 v[32:35], v[116:119], v[144:147], v[32:35]
    ds_read_b128 v[100:103], v241 offset:640
    v_mfma_f32_16x16x32_bf16 v[36:39], v[116:119], v[148:151], v[36:39]
    ds_read_b128 v[104:107], v241 offset:128
    v_mfma_f32_16x16x32_bf16 v[40:43], v[116:119], v[152:155], v[40:43]
    ds_read_b64 v[52:53], v240 offset:640
    v_mfma_f32_16x16x32_bf16 v[44:47], v[116:119], v[156:159], v[44:47]
    ds_read_b64 v[54:55], v240 offset:648
    v_mfma_f32_16x16x32_bf16 v[32:35], v[120:123], v[140:143], v[32:35]
    ds_read_b64 v[56:57], v240 offset:1152
    v_mfma_f32_16x16x32_bf16 v[36:39], v[120:123], v[144:147], v[36:39]
    ds_read_b64 v[58:59], v240 offset:1160
    v_mfma_f32_16x16x32_bf16 v[40:43], v[120:123], v[148:151], v[40:43]
    ds_read_b64 v[60:61], v240 offset:1664
    v_mfma_f32_16x16x32_bf16 v[44:47], v[120:123], v[152:155], v[44:47]
    ds_read_b64 v[62:63], v240 offset:1672
    v_mfma_f32_16x16x32_bf16 v[32:35], v[124:127], v[136:139], v[32:35]
    ds_read_b64 v[64:65], v240 offset:2176
    v_mfma_f32_16x16x32_bf16 v[36:39], v[124:127], v[140:143], v[36:39]
    ds_read_b64 v[66:67], v240 offset:2184
    v_mfma_f32_16x16x32_bf16 v[40:43], v[124:127], v[144:147], v[40:43]
    ds_read_b64 v[68:69], v240 offset:2688
    v_mfma_f32_16x16x32_bf16 v[44:47], v[124:127], v[148:151], v[44:47]
    ds_read_b64 v[70:71], v240 offset:2696
    v_mfma_f32_16x16x32_bf16 v[36:39], v[128:131], v[136:139], v[36:39]
    ds_read_b64 v[72:73], v240 offset:3200
    v_mfma_f32_16x16x32_bf16 v[40:43], v[128:131], v[140:143], v[40:43]
    ds_read_b64 v[74:75], v240 offset:3208
    v_mfma_f32_16x16x32_bf16 v[44:47], v[128:131], v[144:147], v[44:47]
    v_mfma_f32_16x16x32_bf16 v[40:43], v[132:135], v[136:139], v[40:43]
    v_mfma_f32_16x16x32_bf16 v[44:47], v[132:135], v[140:143], v[44:47]
    v_mfma_f32_16x16x32_bf16 v[44:47], v[172:175], v[136:139], v[44:47]
    s_waitcnt lgkmcnt(0)
    v_mfma_f32_16x16x32_bf16 v[32:35], v[48:51], v[92:95], v[32:35]
    ds_read_b64 v[108:109], v240 offset:192
    v_mfma_f32_16x16x32_bf16 v[36:39], v[48:51], v[96:99], v[36:39]
    ds_read_b64 v[110:111], v240 offset:200
    v_mfma_f32_16x16x32_bf16 v[40:43], v[48:51], v[100:103], v[40:43]
    ds_read_b128 v[136:139], v235
    v_mfma_f32_16x16x32_bf16 v[44:47], v[48:51], v[104:107], v[44:47]
    ds_read_b128 v[140:143], v241 offset:3264
    v_mfma_f32_16x16x32_bf16 v[32:35], v[52:55], v[88:91], v[32:35]
    ds_read_b128 v[144:147], v241 offset:2752
    v_mfma_f32_16x16x32_bf16 v[36:39], v[52:55], v[92:95], v[36:39]
    ds_read_b128 v[148:151], v241 offset:2240
    buffer_load_dwordx2 v[200:201], v244, s[64:67], s14 offen offset:0
    v_mfma_f32_16x16x32_bf16 v[40:43], v[52:55], v[96:99], v[40:43]
    ds_read_b128 v[152:155], v241 offset:1728
    v_mfma_f32_16x16x32_bf16 v[44:47], v[52:55], v[100:103], v[44:47]
    ds_read_b128 v[156:159], v241 offset:1216
    v_mfma_f32_16x16x32_bf16 v[32:35], v[56:59], v[84:87], v[32:35]
    ds_read_b128 v[160:163], v241 offset:704
    v_mfma_f32_16x16x32_bf16 v[36:39], v[56:59], v[88:91], v[36:39]
    ds_read_b128 v[164:167], v241 offset:192
    v_mfma_f32_16x16x32_bf16 v[40:43], v[56:59], v[92:95], v[40:43]
    ds_read_b64 v[112:113], v240 offset:704
    v_mfma_f32_16x16x32_bf16 v[44:47], v[56:59], v[96:99], v[44:47]
    ds_read_b64 v[114:115], v240 offset:712
    v_mfma_f32_16x16x32_bf16 v[32:35], v[60:63], v[80:83], v[32:35]
    ds_read_b64 v[116:117], v240 offset:1216
    v_mfma_f32_16x16x32_bf16 v[36:39], v[60:63], v[84:87], v[36:39]
    ds_read_b64 v[118:119], v240 offset:1224
    v_mfma_f32_16x16x32_bf16 v[40:43], v[60:63], v[88:91], v[40:43]
    ds_read_b64 v[120:121], v240 offset:1728
    v_mfma_f32_16x16x32_bf16 v[44:47], v[60:63], v[92:95], v[44:47]
    ds_read_b64 v[122:123], v240 offset:1736
    v_mfma_f32_16x16x32_bf16 v[32:35], v[64:67], v[76:79], v[32:35]
    ds_read_b64 v[124:125], v240 offset:2240
    v_mfma_f32_16x16x32_bf16 v[36:39], v[64:67], v[80:83], v[36:39]
    ds_read_b64 v[126:127], v240 offset:2248
    v_mfma_f32_16x16x32_bf16 v[40:43], v[64:67], v[84:87], v[40:43]
    ds_read_b64 v[128:129], v240 offset:2752
    v_mfma_f32_16x16x32_bf16 v[44:47], v[64:67], v[88:91], v[44:47]
    ds_read_b64 v[130:131], v240 offset:2760
    v_mfma_f32_16x16x32_bf16 v[36:39], v[68:71], v[76:79], v[36:39]
    ds_read_b64 v[132:133], v240 offset:3264
    v_mfma_f32_16x16x32_bf16 v[40:43], v[68:71], v[80:83], v[40:43]
    ds_read_b64 v[134:135], v240 offset:3272
    v_mfma_f32_16x16x32_bf16 v[44:47], v[68:71], v[84:87], v[44:47]
    v_mfma_f32_16x16x32_bf16 v[40:43], v[72:75], v[76:79], v[40:43]
    v_mfma_f32_16x16x32_bf16 v[44:47], v[72:75], v[80:83], v[44:47]
    v_mfma_f32_16x16x32_bf16 v[44:47], v[176:179], v[76:79], v[44:47]
    s_waitcnt lgkmcnt(0)
    v_mfma_f32_16x16x32_bf16 v[32:35], v[108:111], v[152:155], v[32:35]
    ds_read_b64 v[48:49], v240 offset:256
    v_mfma_f32_16x16x32_bf16 v[36:39], v[108:111], v[156:159], v[36:39]
    ds_read_b64 v[50:51], v240 offset:264
    v_mfma_f32_16x16x32_bf16 v[40:43], v[108:111], v[160:163], v[40:43]
    ds_read_b128 v[76:79], v236
    v_mfma_f32_16x16x32_bf16 v[44:47], v[108:111], v[164:167], v[44:47]
    ds_read_b128 v[80:83], v241 offset:3328
    v_mfma_f32_16x16x32_bf16 v[32:35], v[112:115], v[148:151], v[32:35]
    ds_read_b128 v[84:87], v241 offset:2816
    v_mfma_f32_16x16x32_bf16 v[36:39], v[112:115], v[152:155], v[36:39]
    ds_read_b128 v[88:91], v241 offset:2304
    buffer_load_dwordx2 v[202:203], v244, s[64:67], s14 offen offset:1280
    v_mfma_f32_16x16x32_bf16 v[40:43], v[112:115], v[156:159], v[40:43]
    ds_read_b128 v[92:95], v241 offset:1792
    v_mfma_f32_16x16x32_bf16 v[44:47], v[112:115], v[160:163], v[44:47]
    ds_read_b128 v[96:99], v241 offset:1280
    v_mfma_f32_16x16x32_bf16 v[32:35], v[116:119], v[144:147], v[32:35]
    ds_read_b128 v[100:103], v241 offset:768
    v_mfma_f32_16x16x32_bf16 v[36:39], v[116:119], v[148:151], v[36:39]
    ds_read_b128 v[104:107], v241 offset:256
    v_mfma_f32_16x16x32_bf16 v[40:43], v[116:119], v[152:155], v[40:43]
    ds_read_b64 v[52:53], v240 offset:768
    v_mfma_f32_16x16x32_bf16 v[44:47], v[116:119], v[156:159], v[44:47]
    ds_read_b64 v[54:55], v240 offset:776
    v_mfma_f32_16x16x32_bf16 v[32:35], v[120:123], v[140:143], v[32:35]
    ds_read_b64 v[56:57], v240 offset:1280
    v_mfma_f32_16x16x32_bf16 v[36:39], v[120:123], v[144:147], v[36:39]
    ds_read_b64 v[58:59], v240 offset:1288
    v_mfma_f32_16x16x32_bf16 v[40:43], v[120:123], v[148:151], v[40:43]
    ds_read_b64 v[60:61], v240 offset:1792
    v_mfma_f32_16x16x32_bf16 v[44:47], v[120:123], v[152:155], v[44:47]
    ds_read_b64 v[62:63], v240 offset:1800
    v_mfma_f32_16x16x32_bf16 v[32:35], v[124:127], v[136:139], v[32:35]
    ds_read_b64 v[64:65], v240 offset:2304
    v_mfma_f32_16x16x32_bf16 v[36:39], v[124:127], v[140:143], v[36:39]
    ds_read_b64 v[66:67], v240 offset:2312
    v_mfma_f32_16x16x32_bf16 v[40:43], v[124:127], v[144:147], v[40:43]
    ds_read_b64 v[68:69], v240 offset:2816
    v_mfma_f32_16x16x32_bf16 v[44:47], v[124:127], v[148:151], v[44:47]
    ds_read_b64 v[70:71], v240 offset:2824
    v_mfma_f32_16x16x32_bf16 v[36:39], v[128:131], v[136:139], v[36:39]
    ds_read_b64 v[72:73], v240 offset:3328
    v_mfma_f32_16x16x32_bf16 v[40:43], v[128:131], v[140:143], v[40:43]
    ds_read_b64 v[74:75], v240 offset:3336
    v_mfma_f32_16x16x32_bf16 v[44:47], v[128:131], v[144:147], v[44:47]
    v_mfma_f32_16x16x32_bf16 v[40:43], v[132:135], v[136:139], v[40:43]
    v_mfma_f32_16x16x32_bf16 v[44:47], v[132:135], v[140:143], v[44:47]
    v_mfma_f32_16x16x32_bf16 v[44:47], v[180:183], v[136:139], v[44:47]
    s_waitcnt lgkmcnt(0)
    v_mfma_f32_16x16x32_bf16 v[32:35], v[48:51], v[92:95], v[32:35]
    ds_read_b64 v[108:109], v240 offset:320
    v_mfma_f32_16x16x32_bf16 v[36:39], v[48:51], v[96:99], v[36:39]
    ds_read_b64 v[110:111], v240 offset:328
    v_mfma_f32_16x16x32_bf16 v[40:43], v[48:51], v[100:103], v[40:43]
    ds_read_b128 v[136:139], v237
    v_mfma_f32_16x16x32_bf16 v[44:47], v[48:51], v[104:107], v[44:47]
    ds_read_b128 v[140:143], v241 offset:3392
    v_mfma_f32_16x16x32_bf16 v[32:35], v[52:55], v[88:91], v[32:35]
    ds_read_b128 v[144:147], v241 offset:2880
    v_mfma_f32_16x16x32_bf16 v[36:39], v[52:55], v[92:95], v[36:39]
    ds_read_b128 v[148:151], v241 offset:2368
    buffer_load_dwordx2 v[204:205], v244, s[64:67], s14 offen offset:2560
    v_mfma_f32_16x16x32_bf16 v[40:43], v[52:55], v[96:99], v[40:43]
    ds_read_b128 v[152:155], v241 offset:1856
    v_mfma_f32_16x16x32_bf16 v[44:47], v[52:55], v[100:103], v[44:47]
    ds_read_b128 v[156:159], v241 offset:1344
    v_mfma_f32_16x16x32_bf16 v[32:35], v[56:59], v[84:87], v[32:35]
    ds_read_b128 v[160:163], v241 offset:832
    v_mfma_f32_16x16x32_bf16 v[36:39], v[56:59], v[88:91], v[36:39]
    ds_read_b128 v[164:167], v241 offset:320
    v_mfma_f32_16x16x32_bf16 v[40:43], v[56:59], v[92:95], v[40:43]
    ds_read_b64 v[112:113], v240 offset:832
    v_mfma_f32_16x16x32_bf16 v[44:47], v[56:59], v[96:99], v[44:47]
    ds_read_b64 v[114:115], v240 offset:840
    v_mfma_f32_16x16x32_bf16 v[32:35], v[60:63], v[80:83], v[32:35]
    ds_read_b64 v[116:117], v240 offset:1344
    v_mfma_f32_16x16x32_bf16 v[36:39], v[60:63], v[84:87], v[36:39]
    ds_read_b64 v[118:119], v240 offset:1352
    v_mfma_f32_16x16x32_bf16 v[40:43], v[60:63], v[88:91], v[40:43]
    ds_read_b64 v[120:121], v240 offset:1856
    v_mfma_f32_16x16x32_bf16 v[44:47], v[60:63], v[92:95], v[44:47]
    ds_read_b64 v[122:123], v240 offset:1864
    v_mfma_f32_16x16x32_bf16 v[32:35], v[64:67], v[76:79], v[32:35]
    ds_read_b64 v[124:125], v240 offset:2368
    v_mfma_f32_16x16x32_bf16 v[36:39], v[64:67], v[80:83], v[36:39]
    ds_read_b64 v[126:127], v240 offset:2376
    v_mfma_f32_16x16x32_bf16 v[40:43], v[64:67], v[84:87], v[40:43]
    ds_read_b64 v[128:129], v240 offset:2880
    v_mfma_f32_16x16x32_bf16 v[44:47], v[64:67], v[88:91], v[44:47]
    ds_read_b64 v[130:131], v240 offset:2888
    v_mfma_f32_16x16x32_bf16 v[36:39], v[68:71], v[76:79], v[36:39]
    ds_read_b64 v[132:133], v240 offset:3392
    v_mfma_f32_16x16x32_bf16 v[40:43], v[68:71], v[80:83], v[40:43]
    ds_read_b64 v[134:135], v240 offset:3400
    v_mfma_f32_16x16x32_bf16 v[44:47], v[68:71], v[84:87], v[44:47]
    v_mfma_f32_16x16x32_bf16 v[40:43], v[72:75], v[76:79], v[40:43]
    v_mfma_f32_16x16x32_bf16 v[44:47], v[72:75], v[80:83], v[44:47]
    v_mfma_f32_16x16x32_bf16 v[44:47], v[184:187], v[76:79], v[44:47]
    s_waitcnt lgkmcnt(0)
    v_mfma_f32_16x16x32_bf16 v[32:35], v[108:111], v[152:155], v[32:35]
    ds_read_b64 v[48:49], v240 offset:384
    v_mfma_f32_16x16x32_bf16 v[36:39], v[108:111], v[156:159], v[36:39]
    ds_read_b64 v[50:51], v240 offset:392
    v_mfma_f32_16x16x32_bf16 v[40:43], v[108:111], v[160:163], v[40:43]
    ds_read_b128 v[76:79], v238
    v_mfma_f32_16x16x32_bf16 v[44:47], v[108:111], v[164:167], v[44:47]
    ds_read_b128 v[80:83], v241 offset:3456
    v_mfma_f32_16x16x32_bf16 v[32:35], v[112:115], v[148:151], v[32:35]
    ds_read_b128 v[84:87], v241 offset:2944
    v_mfma_f32_16x16x32_bf16 v[36:39], v[112:115], v[152:155], v[36:39]
    ds_read_b128 v[88:91], v241 offset:2432
    buffer_load_dwordx2 v[206:207], v244, s[64:67], s14 offen offset:3840
    v_mfma_f32_16x16x32_bf16 v[40:43], v[112:115], v[156:159], v[40:43]
    ds_read_b128 v[92:95], v241 offset:1920
    v_mfma_f32_16x16x32_bf16 v[44:47], v[112:115], v[160:163], v[44:47]
    ds_read_b128 v[96:99], v241 offset:1408
    v_mfma_f32_16x16x32_bf16 v[32:35], v[116:119], v[144:147], v[32:35]
    ds_read_b128 v[100:103], v241 offset:896
    v_mfma_f32_16x16x32_bf16 v[36:39], v[116:119], v[148:151], v[36:39]
    ds_read_b128 v[104:107], v241 offset:384
    v_mfma_f32_16x16x32_bf16 v[40:43], v[116:119], v[152:155], v[40:43]
    ds_read_b64 v[52:53], v240 offset:896
    v_mfma_f32_16x16x32_bf16 v[44:47], v[116:119], v[156:159], v[44:47]
    ds_read_b64 v[54:55], v240 offset:904
    v_mfma_f32_16x16x32_bf16 v[32:35], v[120:123], v[140:143], v[32:35]
    ds_read_b64 v[56:57], v240 offset:1408
    v_mfma_f32_16x16x32_bf16 v[36:39], v[120:123], v[144:147], v[36:39]
    ds_read_b64 v[58:59], v240 offset:1416
    v_mfma_f32_16x16x32_bf16 v[40:43], v[120:123], v[148:151], v[40:43]
    ds_read_b64 v[60:61], v240 offset:1920
    v_mfma_f32_16x16x32_bf16 v[44:47], v[120:123], v[152:155], v[44:47]
    ds_read_b64 v[62:63], v240 offset:1928
    v_mfma_f32_16x16x32_bf16 v[32:35], v[124:127], v[136:139], v[32:35]
    ds_read_b64 v[64:65], v240 offset:2432
    v_mfma_f32_16x16x32_bf16 v[36:39], v[124:127], v[140:143], v[36:39]
    ds_read_b64 v[66:67], v240 offset:2440
    v_mfma_f32_16x16x32_bf16 v[40:43], v[124:127], v[144:147], v[40:43]
    ds_read_b64 v[68:69], v240 offset:2944
    v_mfma_f32_16x16x32_bf16 v[44:47], v[124:127], v[148:151], v[44:47]
    ds_read_b64 v[70:71], v240 offset:2952
    v_mfma_f32_16x16x32_bf16 v[36:39], v[128:131], v[136:139], v[36:39]
    ds_read_b64 v[72:73], v240 offset:3456
    v_mfma_f32_16x16x32_bf16 v[40:43], v[128:131], v[140:143], v[40:43]
    ds_read_b64 v[74:75], v240 offset:3464
    v_mfma_f32_16x16x32_bf16 v[44:47], v[128:131], v[144:147], v[44:47]
    v_mfma_f32_16x16x32_bf16 v[40:43], v[132:135], v[136:139], v[40:43]
    v_mfma_f32_16x16x32_bf16 v[44:47], v[132:135], v[140:143], v[44:47]
    v_mfma_f32_16x16x32_bf16 v[44:47], v[188:191], v[136:139], v[44:47]
    s_waitcnt lgkmcnt(0)
    v_mfma_f32_16x16x32_bf16 v[32:35], v[48:51], v[92:95], v[32:35]
    ds_read_b64 v[108:109], v240 offset:448
    v_mfma_f32_16x16x32_bf16 v[36:39], v[48:51], v[96:99], v[36:39]
    ds_read_b64 v[110:111], v240 offset:456
    v_mfma_f32_16x16x32_bf16 v[40:43], v[48:51], v[100:103], v[40:43]
    ds_read_b128 v[136:139], v239
    v_mfma_f32_16x16x32_bf16 v[44:47], v[48:51], v[104:107], v[44:47]
    ds_read_b128 v[140:143], v241 offset:3520
    v_mfma_f32_16x16x32_bf16 v[32:35], v[52:55], v[88:91], v[32:35]
    ds_read_b128 v[144:147], v241 offset:3008
    v_mfma_f32_16x16x32_bf16 v[36:39], v[52:55], v[92:95], v[36:39]
    ds_read_b128 v[148:151], v241 offset:2496
    v_mfma_f32_16x16x32_bf16 v[40:43], v[52:55], v[96:99], v[40:43]
    ds_read_b128 v[152:155], v241 offset:1984
    v_mfma_f32_16x16x32_bf16 v[44:47], v[52:55], v[100:103], v[44:47]
    ds_read_b128 v[156:159], v241 offset:1472
    v_mfma_f32_16x16x32_bf16 v[32:35], v[56:59], v[84:87], v[32:35]
    ds_read_b128 v[160:163], v241 offset:960
    v_mfma_f32_16x16x32_bf16 v[36:39], v[56:59], v[88:91], v[36:39]
    ds_read_b128 v[164:167], v241 offset:448
    v_mfma_f32_16x16x32_bf16 v[40:43], v[56:59], v[92:95], v[40:43]
    ds_read_b64 v[112:113], v240 offset:960
    v_mfma_f32_16x16x32_bf16 v[44:47], v[56:59], v[96:99], v[44:47]
    ds_read_b64 v[114:115], v240 offset:968
    v_mfma_f32_16x16x32_bf16 v[32:35], v[60:63], v[80:83], v[32:35]
    ds_read_b64 v[116:117], v240 offset:1472
    v_mfma_f32_16x16x32_bf16 v[36:39], v[60:63], v[84:87], v[36:39]
    ds_read_b64 v[118:119], v240 offset:1480
    v_mfma_f32_16x16x32_bf16 v[40:43], v[60:63], v[88:91], v[40:43]
    ds_read_b64 v[120:121], v240 offset:1984
    v_mfma_f32_16x16x32_bf16 v[44:47], v[60:63], v[92:95], v[44:47]
    ds_read_b64 v[122:123], v240 offset:1992
    v_mfma_f32_16x16x32_bf16 v[32:35], v[64:67], v[76:79], v[32:35]
    ds_read_b64 v[124:125], v240 offset:2496
    v_mfma_f32_16x16x32_bf16 v[36:39], v[64:67], v[80:83], v[36:39]
    ds_read_b64 v[126:127], v240 offset:2504
    v_mfma_f32_16x16x32_bf16 v[40:43], v[64:67], v[84:87], v[40:43]
    ds_read_b64 v[128:129], v240 offset:3008
    v_mfma_f32_16x16x32_bf16 v[44:47], v[64:67], v[88:91], v[44:47]
    ds_read_b64 v[130:131], v240 offset:3016
    v_mfma_f32_16x16x32_bf16 v[36:39], v[68:71], v[76:79], v[36:39]
    ds_read_b64 v[132:133], v240 offset:3520
    v_mfma_f32_16x16x32_bf16 v[40:43], v[68:71], v[80:83], v[40:43]
    ds_read_b64 v[134:135], v240 offset:3528
    v_mfma_f32_16x16x32_bf16 v[44:47], v[68:71], v[84:87], v[44:47]
    v_mfma_f32_16x16x32_bf16 v[40:43], v[72:75], v[76:79], v[40:43]
    v_mfma_f32_16x16x32_bf16 v[44:47], v[72:75], v[80:83], v[44:47]
    v_mfma_f32_16x16x32_bf16 v[44:47], v[192:195], v[76:79], v[44:47]
    s_waitcnt lgkmcnt(0)
    v_mfma_f32_16x16x32_bf16 v[32:35], v[108:111], v[152:155], v[32:35]
    v_add_u32 v4, 40960, v246
    v_mfma_f32_16x16x32_bf16 v[32:35], v[112:115], v[148:151], v[32:35]
    s_waitcnt vmcnt(0)
    v_lshlrev_b32 v48, 16, v200
    v_and_b32 v49, s82, v200
    v_mfma_f32_16x16x32_bf16 v[32:35], v[116:119], v[144:147], v[32:35]
    v_lshlrev_b32 v50, 16, v201
    v_and_b32 v51, s82, v201
    v_mfma_f32_16x16x32_bf16 v[32:35], v[120:123], v[140:143], v[32:35]
    v_lshlrev_b32 v52, 16, v202
    v_and_b32 v53, s82, v202
    v_mfma_f32_16x16x32_bf16 v[32:35], v[124:127], v[136:139], v[32:35]
    v_lshlrev_b32 v54, 16, v203
    v_and_b32 v55, s82, v203
    v_mfma_f32_16x16x32_bf16 v[36:39], v[108:111], v[156:159], v[36:39]
    v_lshlrev_b32 v56, 16, v204
    v_and_b32 v57, s82, v204
    v_mfma_f32_16x16x32_bf16 v[36:39], v[112:115], v[152:155], v[36:39]
    v_lshlrev_b32 v58, 16, v205
    v_and_b32 v59, s82, v205
    v_mfma_f32_16x16x32_bf16 v[36:39], v[116:119], v[148:151], v[36:39]
    v_lshlrev_b32 v60, 16, v206
    v_and_b32 v61, s82, v206
    v_mfma_f32_16x16x32_bf16 v[36:39], v[120:123], v[144:147], v[36:39]
    v_lshlrev_b32 v62, 16, v207
    v_and_b32 v63, s82, v207
    v_mfma_f32_16x16x32_bf16 v[36:39], v[124:127], v[140:143], v[36:39]
    v_mfma_f32_16x16x32_bf16 v[36:39], v[128:131], v[136:139], v[36:39]
    v_mfma_f32_16x16x32_bf16 v[40:43], v[108:111], v[160:163], v[40:43]
    v_mfma_f32_16x16x32_bf16 v[40:43], v[112:115], v[156:159], v[40:43]
    ds_write_b128 v243, v[32:35] offset:4096
    v_mfma_f32_16x16x32_bf16 v[40:43], v[116:119], v[152:155], v[40:43]
    v_mfma_f32_16x16x32_bf16 v[40:43], v[120:123], v[148:151], v[40:43]
    v_mfma_f32_16x16x32_bf16 v[40:43], v[124:127], v[144:147], v[40:43]
    v_mfma_f32_16x16x32_bf16 v[40:43], v[128:131], v[140:143], v[40:43]
    v_mfma_f32_16x16x32_bf16 v[40:43], v[132:135], v[136:139], v[40:43]
    v_mfma_f32_16x16x32_bf16 v[44:47], v[108:111], v[164:167], v[44:47]
    ds_write_b128 v243, v[36:39] offset:5120
    v_mfma_f32_16x16x32_bf16 v[44:47], v[112:115], v[160:163], v[44:47]
    v_mfma_f32_16x16x32_bf16 v[44:47], v[116:119], v[156:159], v[44:47]
    v_mfma_f32_16x16x32_bf16 v[44:47], v[120:123], v[152:155], v[44:47]
    v_mfma_f32_16x16x32_bf16 v[44:47], v[124:127], v[148:151], v[44:47]
    v_mfma_f32_16x16x32_bf16 v[44:47], v[128:131], v[144:147], v[44:47]
    v_mfma_f32_16x16x32_bf16 v[44:47], v[132:135], v[140:143], v[44:47]
    v_mfma_f32_16x16x32_bf16 v[44:47], v[196:199], v[136:139], v[44:47]
    ds_write_b128 v243, v[40:43] offset:6144
    s_nop 6
    ds_write_b128 v243, v[44:47] offset:7168
Lfin_22:
    s_waitcnt lgkmcnt(0)
    s_barrier
    ds_read_b128 v[72:75], v246 offset:4096
    ds_read_b128 v[76:79], v246 offset:24576
    ds_read_b128 v[80:83], v4 offset:4096
    ds_read_b128 v[84:87], v4 offset:24576
    s_lshl_b32 s13, s6, 5
    s_add_u32 s13, s13, 5242880
    s_waitcnt lgkmcnt(0)
    v_mul_f32 v48, v48, v72
    v_mul_f32 v49, v49, v76
    v_mul_f32 v50, v50, v80
    v_mul_f32 v51, v51, v84
    buffer_store_dwordx4 v[48:51], v245, s[72:75], s13 offen
    s_add_u32 s13, s13, 5120
    v_mul_f32 v52, v52, v73
    v_mul_f32 v53, v53, v77
    v_mul_f32 v54, v54, v81
    v_mul_f32 v55, v55, v85
    buffer_store_dwordx4 v[52:55], v245, s[72:75], s13 offen
    s_add_u32 s13, s13, 5120
    v_mul_f32 v56, v56, v74
    v_mul_f32 v57, v57, v78
    v_mul_f32 v58, v58, v82
    v_mul_f32 v59, v59, v86
    buffer_store_dwordx4 v[56:59], v245, s[72:75], s13 offen
    s_add_u32 s13, s13, 5120
    v_mul_f32 v60, v60, v75
    v_mul_f32 v61, v61, v79
    v_mul_f32 v62, v62, v83
    v_mul_f32 v63, v63, v87
    buffer_store_dwordx4 v[60:63], v245, s[72:75], s13 offen
    s_endpgm
L_roleP:
    s_and_b32 s13, s4, 1
    s_lshl_b32 s13, s13, 8
    v_add_u32 v1, s13, v0
    v_mul_u32_u24 v1, 1280, v1
    s_mov_b32 s8, s3
    s_waitcnt lgkmcnt(0)
    s_cmp_eq_u32 s5, 30
    s_cselect_b32 s52, s38, s40
    s_cselect_b32 s53, s39, s41
    s_mov_b32 s54, 819200
    s_mov_b32 s55, 0x20000
Lpf_27:
    s_mul_i32 s9, s8, 43
    s_lshr_b32 s9, s9, 8
    s_mul_i32 s10, s9, 6
    s_sub_u32 s10, s8, s10
    s_mul_i32 s10, s10, 81920
    s_lshl_b32 s9, s9, 7
    s_add_u32 s10, s10, s9
    buffer_load_dword v4, v1, s[52:55], s10 offen
    s_add_u32 s8, s8, 8
    s_cmp_lt_u32 s8, 60
    s_cbranch_scc1 Lpf_27
    s_waitcnt vmcnt(0)
    s_endpgm
L_exit:
    s_endpgm
.section .rodata,"a"
.p2align 6
.amdhsa_kernel concat_heads__ssm_conv_h3__ssm_conv_s5__prompt_kernel
  .amdhsa_next_free_vgpr 256
  .amdhsa_next_free_sgpr 102
  .amdhsa_accum_offset 256
  .amdhsa_group_segment_fixed_size 0
  .amdhsa_kernarg_size 144
  .amdhsa_user_sgpr_count 2
  .amdhsa_user_sgpr_kernarg_segment_ptr 1
  .amdhsa_system_sgpr_workgroup_id_x 1
  .amdhsa_float_denorm_mode_32 3
.end_amdhsa_kernel
```
